```python
import torch

def _softmax(x, axis=-1):
    return torch.softmax(x, dim=axis)
def _gelu(x):
    return torch.nn.functional.gelu(x, approximate="tanh")
def _silu(x):
    return torch.nn.functional.silu(x)
def _sigmoid(x):
    return torch.sigmoid(x)
def _layernorm(x, axis=-1, eps=1e-5):
    m = x.mean(dim=axis, keepdim=True)
    v = x.var(dim=axis, keepdim=True, unbiased=False)
    return (x - m) / torch.sqrt(v + eps)
def _scatter_add(tgt, idx, src, axis=0):
    return tgt.clone().index_add_(axis, idx, src)
def _segment_sum(src, seg, n):
    out = torch.zeros((n,) + src.shape[1:], dtype=src.dtype)
    return out.index_add_(0, seg, src)
def _pad(x, pw):
    flat = tuple(v for pair in reversed(pw) for v in pair)
    return torch.nn.functional.pad(x, flat)

kernel_name = 'gated_mix__sliding_block_cached__dense_activation_relu__decode'

def setup_inputs():

    _w = (lambda a: (lambda t: t.to(torch.bfloat16) if t.is_floating_point() else t)(torch.as_tensor(a)))
    def _A_setup():
        B, Sq, D = 2, 1, 576
        Hq, Hkv, Sk, Dh = 32, 16, 8192, 128
        assert Hq % Hkv == 0, (Hq, Hkv)
        return {
            "x": _w((lambda *s: torch.randn(*s, dtype=torch.bfloat16) * 0.05)(B, Sq, D)),
            "k_cache": _w((lambda *s: torch.randn(*s, dtype=torch.bfloat16) * 6.4)(B, Hkv, Sk, Dh)),
            "v_cache": _w((lambda *s: torch.randn(*s, dtype=torch.bfloat16) * 1.6)(B, Hkv, Sk, Dh)),
            "wq": _w((lambda *s: torch.randn(*s, dtype=torch.bfloat16) * 6.4)(D, Hq * Dh) * (D ** -0.5)),
            "wo": _w((lambda *s: torch.randn(*s, dtype=torch.bfloat16) * 1.6)(Hq * Dh, D) * ((Hq * Dh) ** -0.5)),
        }
    _A_in = _A_setup()

    def _B_setup():
        B, S, D, Dff = 2, 1, 576, 4608
        return {
            "x": _w((lambda *s: torch.randn(*s, dtype=torch.bfloat16) * 0.05)(B, S, D)),
            "w1": _w((lambda *s: torch.randn(*s, dtype=torch.bfloat16) * 0.05)(D, Dff)),
            "w2": _w((lambda *s: torch.randn(*s, dtype=torch.bfloat16) * 0.05)(Dff, D)),
        }
    _B_in = _B_setup()

    return {
        "A_x": _A_in["x"],
        "A_k_cache": _A_in["k_cache"],
        "A_v_cache": _A_in["v_cache"],
        "A_wq": _A_in["wq"],
        "A_wo": _A_in["wo"],
        "B_x": _B_in["x"],
        "B_w1": _B_in["w1"],
        "B_w2": _B_in["w2"],
        "gate_w": _w((lambda *s: torch.randn(*s, dtype=torch.bfloat16) * 0.05)(576) * 16.0),
    }

def reference(A_x, A_k_cache, A_v_cache, A_wq, A_wo, B_x, B_w1, B_w2, gate_w):
    def _A_ref(x, k_cache, v_cache, wq, wo):
        B, Sq, D = x.shape
        Hq, Dh = 32, 128
        Hkv, Sk = k_cache.shape[1], k_cache.shape[2]
        W = min(4096, max(256, Sk // 4))
        rep = Hq // Hkv
        q = (lambda x, *d: x.permute(*d))((x @ wq).reshape(B, Sq, Hq, Dh), 0, 2, 1, 3)
        k = (lambda x, n, axis: torch.repeat_interleave(x, n, dim=axis))(k_cache[:, :, Sk - W:, :], rep, axis=1)
        v = (lambda x, n, axis: torch.repeat_interleave(x, n, dim=axis))(v_cache[:, :, Sk - W:, :], rep, axis=1)
        scores = torch.einsum("bhqd,bhkd->bhqk", q, k) * (Dh ** -0.5)
        p = _softmax(scores, axis=-1)
        o = torch.einsum("bhqk,bhkd->bhqd", p, v)
        return (lambda x, *d: x.permute(*d))(o, 0, 2, 1, 3).reshape(B, Sq, Hq * Dh) @ wo

    def _B_ref(x, w1, w2):
        h = torch.einsum("bsd,df->bsf", x, w1)
        zero = torch.zeros_like(h)
        h = torch.maximum(h, zero)
        return torch.einsum("bsf,fd->bsd", h, w2)

    x = A_x
    g = _sigmoid((x * gate_w).sum(-1, keepdims=True))
    a = _A_ref(x, A_k_cache, A_v_cache, A_wq, A_wo)
    b = _B_ref(x, B_w1, B_w2)
    return g * a + (1 - g) * b
```

```asm
; @launch grid=(256,1,1) block=(832,1,1) lds=139776
.amdgcn_target "amdgcn-amd-amdhsa--gfx950"
.text
.globl gated_mix__sliding_block_cached__dense_activation_relu__decode_kernel
.p2align 8
.type gated_mix__sliding_block_cached__dense_activation_relu__decode_kernel,@function
gated_mix__sliding_block_cached__dense_activation_relu__decode_kernel:
s_cmp_ge_u32 s2, 256
s_cbranch_scc1 L_end
s_load_dwordx16 s[16:31], s[0:1], 0
s_load_dwordx8 s[32:39], s[0:1], 64
v_lshrrev_b32 v1, 6, v0
v_and_b32 v0, 63, v0
s_and_b32 s4, s2, 7
v_readfirstlane_b32 s3, v1
s_lshl_b32 s4, s4, 1
s_bfe_u32 s5, s2, 0x10003
s_add_u32 s4, s4, s5
s_bfe_u32 s5, s2, 0x10004
s_lshr_b32 s6, s2, 5
s_lshr_b32 s7, s2, 4
v_and_b32 v1, 15, v0
v_lshrrev_b32 v2, 4, v0
s_cmp_lg_u32 s3, 0
s_cbranch_scc1 L_nopf
s_getpc_b64 s[10:11]
s_and_b32 s10, s10, 0xffffff00
s_lshr_b32 s8, s2, 3
s_mul_i32 s8, s8, 0x4
v_add_u32 v3, s8, v0
v_subrev_u32 v4, 0x6b, v3
v_min_u32 v3, v3, v4
v_lshlrev_b32 v3, 7, v3
s_mov_b32 exec_lo, 0xffffff
s_mov_b32 exec_hi, 0x0
global_load_dword v127, v3, s[10:11]
s_mov_b64 exec, -1
L_nopf:
s_cmp_gt_u32 s3, 1
s_cbranch_scc1 L_disp
s_setprio 3
s_mul_i32 s9, s2, 293
s_lshr_b32 s9, s9, 11
s_mul_i32 s10, s9, 7
s_sub_u32 s10, s2, s10
s_mul_i32 s11, s10, 88
s_mul_i32 s12, s10, 80
s_add_u32 s12, s12, 16
s_min_u32 s11, s11, s12
s_cmp_lt_u32 s10, 2
s_cselect_b32 s14, 22, 20
s_cselect_b32 s57, 0, 0x7f000000
s_lshl_b32 s15, s9, 8
s_cmp_ge_u32 s2, 252
s_cselect_b32 s15, 0x7f000000, s15
s_lshr_b32 s12, s7, 1
s_mul_i32 s13, s12, 72
s_and_b32 s8, s7, 1
s_lshl_b32 s58, s4, 1
s_add_u32 s58, s58, s8
s_lshl_b32 s59, s58, 8
s_lshl_b32 s43, s3, 10
s_add_u32 s43, s43, 8192
s_cmp_eq_u32 s3, 0
s_cselect_b32 s11, s13, s11
s_cselect_b32 s14, 18, s14
s_cselect_b32 s15, s59, s15
s_cselect_b32 s56, 0x7f000000, 0
s_cselect_b32 s57, 0, s57
s_mul_i32 s8, s14, s43
v_mul_u32_u24 v3, s8, v2
v_lshl_add_u32 v3, v1, 4, v3
v_bfe_u32 v4, v0, 3, 1
v_mul_u32_u24 v4, 1152, v4
s_lshl_b32 s8, s14, 1
v_mul_u32_u24 v5, s8, v2
v_add_u32 v4, v4, v5
s_lshl_b32 s8, s11, 1
s_mul_i32 s11, s11, s43
s_add_u32 s11, s11, s15
s_mul_i32 s50, s43, 576
s_mov_b32 s51, 0x20000
s_mov_b32 s46, 2304
s_mov_b32 s47, 0x20000
s_cmp_eq_u32 s3, 0
s_waitcnt lgkmcnt(0)
s_load_dword s40, s[38:39], 0
s_mov_b32 s44, s16
s_mov_b32 s45, s17
s_cselect_b32 s48, s22, s28
s_cselect_b32 s49, s23, s29
buffer_load_dwordx4 v[16:19], v4, s[44:47], s8 offen
buffer_load_dwordx4 v[20:23], v4, s[44:47], s8 offen offset:16
buffer_load_dwordx3 v[24:26], v4, s[44:47], s8 offen offset:32
buffer_load_dwordx4 v[32:35], v3, s[48:51], s11 offen nt
s_add_u32 s11, s11, s43
buffer_load_dwordx4 v[36:39], v3, s[48:51], s11 offen nt
s_add_u32 s11, s11, s43
buffer_load_dwordx4 v[40:43], v3, s[48:51], s11 offen nt
s_add_u32 s11, s11, s43
buffer_load_dwordx4 v[44:47], v3, s[48:51], s11 offen nt
s_add_u32 s11, s11, s43
buffer_load_dwordx4 v[48:51], v3, s[48:51], s11 offen nt
s_add_u32 s11, s11, s43
buffer_load_dwordx4 v[52:55], v3, s[48:51], s11 offen nt
s_add_u32 s11, s11, s43
buffer_load_dwordx4 v[56:59], v3, s[48:51], s11 offen nt
s_add_u32 s11, s11, s43
buffer_load_dwordx4 v[60:63], v3, s[48:51], s11 offen nt
s_add_u32 s11, s11, s43
buffer_load_dwordx4 v[64:67], v3, s[48:51], s11 offen nt
s_add_u32 s11, s11, s43
buffer_load_dwordx4 v[68:71], v3, s[48:51], s11 offen nt
s_add_u32 s11, s11, s43
buffer_load_dwordx4 v[72:75], v3, s[48:51], s11 offen nt
s_add_u32 s11, s11, s43
buffer_load_dwordx4 v[76:79], v3, s[48:51], s11 offen nt
s_add_u32 s11, s11, s43
buffer_load_dwordx4 v[80:83], v3, s[48:51], s11 offen nt
s_add_u32 s11, s11, s43
buffer_load_dwordx4 v[84:87], v3, s[48:51], s11 offen nt
s_add_u32 s11, s11, s43
buffer_load_dwordx4 v[88:91], v3, s[48:51], s11 offen nt
s_add_u32 s11, s11, s43
buffer_load_dwordx4 v[92:95], v3, s[48:51], s11 offen nt
s_add_u32 s11, s11, s43
buffer_load_dwordx4 v[96:99], v3, s[48:51], s11 offen nt
s_add_u32 s11, s11, s43
buffer_load_dwordx4 v[100:103], v3, s[48:51], s11 offen nt
s_add_u32 s11, s11, s43
s_add_u32 s11, s11, s56
buffer_load_dwordx4 v[104:107], v3, s[48:51], s11 offen nt
s_add_u32 s11, s11, s43
buffer_load_dwordx4 v[108:111], v3, s[48:51], s11 offen nt
s_add_u32 s11, s11, s43
s_add_u32 s11, s11, s57
buffer_load_dwordx4 v[112:115], v3, s[48:51], s11 offen nt
s_add_u32 s11, s11, s43
buffer_load_dwordx4 v[116:119], v3, s[48:51], s11 offen nt
s_barrier
s_branch L_QH2
L_disp:
s_cmp_eq_u32 s3, 2
s_cbranch_scc1 L_L
v_mov_b32 v4, 0
v_lshlrev_b32 v5, 2, v0
v_add_u32 v5, 0x20600, v5
ds_write_b32 v5, v4
s_waitcnt lgkmcnt(0)
s_load_dword s40, s[38:39], 0
s_mov_b32 s52, s38
s_mov_b32 s53, s39
s_mov_b32 s54, 0x268000
s_mov_b32 s55, 0x20000
s_mov_b32 s41, 0xfff
s_barrier
s_cmp_eq_u32 s3, 3
s_cbranch_scc1 L_X
s_cmp_ge_u32 s3, 8
s_cbranch_scc1 L_W
s_branch L_C
L_L:
s_setprio 3
v_add_u32 v8, 0, v2
v_xor_b32 v8, v8, v1
v_lshlrev_b32 v8, 4, v8
v_lshl_add_u32 v12, v2, 8, v8
v_add_u32 v8, 4, v2
v_xor_b32 v8, v8, v1
v_lshlrev_b32 v8, 4, v8
v_lshl_add_u32 v13, v2, 8, v8
v_add_u32 v8, 8, v2
v_xor_b32 v8, v8, v1
v_lshlrev_b32 v8, 4, v8
v_lshl_add_u32 v14, v2, 8, v8
v_add_u32 v8, 12, v2
v_xor_b32 v8, v8, v1
v_lshlrev_b32 v8, 4, v8
v_lshl_add_u32 v15, v2, 8, v8
s_lshl_b32 s12, s5, 4
s_add_u32 s12, s12, s4
s_lshl_b32 s12, s12, 21
s_lshl_b32 s13, s6, 16
s_add_u32 s12, s12, s13
s_add_u32 s12, s12, 0x180000
s_lshr_b32 s13, s2, 3
s_add_u32 s13, s13, s2
s_lshl_b32 s13, s13, 12
s_mov_b32 s46, 0x4000000
s_mov_b32 s47, 0x20000
s_mov_b32 s50, 0x4000000
s_mov_b32 s51, 0x20000
v_lshlrev_b32 v3, 4, v0
v_mov_b32 v9, 0x20650
s_waitcnt lgkmcnt(0)
s_mov_b32 s44, s18
s_mov_b32 s45, s19
s_mov_b32 s48, s20
s_mov_b32 s49, s21
s_load_dword s40, s[38:39], 0
s_mov_b32 s52, s38
s_mov_b32 s53, s39
s_mov_b32 s54, 0x268000
s_mov_b32 s55, 0x20000
s_mov_b32 s41, 0xfff
s_barrier
s_and_b32 s14, s13, 0xf000
s_add_u32 s14, s14, s12
s_add_u32 s13, s13, 0x1000
s_mov_b32 m0, 0x0
s_nop 0
buffer_load_dwordx4 v12, s[44:47], s14 offen offset:0 nt lds
buffer_load_dwordx4 v13, s[44:47], s14 offen offset:1024 nt lds
buffer_load_dwordx4 v14, s[44:47], s14 offen offset:2048 nt lds
buffer_load_dwordx4 v15, s[44:47], s14 offen offset:3072 nt lds
s_and_b32 s14, s13, 0xf000
s_add_u32 s14, s14, s12
s_add_u32 s13, s13, 0x1000
s_mov_b32 m0, 0x1000
s_nop 0
buffer_load_dwordx4 v12, s[44:47], s14 offen offset:0 nt lds
buffer_load_dwordx4 v13, s[44:47], s14 offen offset:1024 nt lds
buffer_load_dwordx4 v14, s[44:47], s14 offen offset:2048 nt lds
buffer_load_dwordx4 v15, s[44:47], s14 offen offset:3072 nt lds
s_and_b32 s14, s13, 0xf000
s_add_u32 s14, s14, s12
s_add_u32 s13, s13, 0x1000
s_mov_b32 m0, 0x2000
s_nop 0
buffer_load_dwordx4 v12, s[44:47], s14 offen offset:0 nt lds
buffer_load_dwordx4 v13, s[44:47], s14 offen offset:1024 nt lds
buffer_load_dwordx4 v14, s[44:47], s14 offen offset:2048 nt lds
buffer_load_dwordx4 v15, s[44:47], s14 offen offset:3072 nt lds
s_and_b32 s14, s13, 0xf000
s_add_u32 s14, s14, s12
s_add_u32 s13, s13, 0x1000
s_mov_b32 m0, 0x3000
s_nop 0
buffer_load_dwordx4 v12, s[44:47], s14 offen offset:0 nt lds
buffer_load_dwordx4 v13, s[44:47], s14 offen offset:1024 nt lds
buffer_load_dwordx4 v14, s[44:47], s14 offen offset:2048 nt lds
buffer_load_dwordx4 v15, s[44:47], s14 offen offset:3072 nt lds
s_and_b32 s14, s13, 0xf000
s_add_u32 s14, s14, s12
s_add_u32 s13, s13, 0x1000
s_mov_b32 m0, 0x4000
s_nop 0
buffer_load_dwordx4 v12, s[44:47], s14 offen offset:0 nt lds
buffer_load_dwordx4 v13, s[44:47], s14 offen offset:1024 nt lds
buffer_load_dwordx4 v14, s[44:47], s14 offen offset:2048 nt lds
buffer_load_dwordx4 v15, s[44:47], s14 offen offset:3072 nt lds
s_waitcnt lgkmcnt(0)
s_add_u32 s42, s40, 1
s_and_b32 s40, s42, s41
v_mov_b32 v7, s40
s_barrier
s_and_b32 s14, s13, 0xf000
s_add_u32 s14, s14, s12
s_add_u32 s13, s13, 0x1000
s_mov_b32 m0, 0x5000
s_waitcnt vmcnt(19)
buffer_load_dwordx4 v12, s[44:47], s14 offen offset:0 nt lds
buffer_load_dwordx4 v13, s[44:47], s14 offen offset:1024 nt lds
buffer_load_dwordx4 v14, s[44:47], s14 offen offset:2048 nt lds
buffer_load_dwordx4 v15, s[44:47], s14 offen offset:3072 nt lds
s_and_b32 s14, s13, 0xf000
s_add_u32 s14, s14, s12
s_add_u32 s13, s13, 0x1000
s_mov_b32 m0, 0x6000
s_nop 0
buffer_load_dwordx4 v12, s[44:47], s14 offen offset:0 nt lds
buffer_load_dwordx4 v13, s[44:47], s14 offen offset:1024 nt lds
buffer_load_dwordx4 v14, s[44:47], s14 offen offset:2048 nt lds
buffer_load_dwordx4 v15, s[44:47], s14 offen offset:3072 nt lds
s_and_b32 s14, s13, 0xf000
s_add_u32 s14, s14, s12
s_add_u32 s13, s13, 0x1000
s_mov_b32 m0, 0x7000
s_nop 0
buffer_load_dwordx4 v12, s[44:47], s14 offen offset:0 nt lds
buffer_load_dwordx4 v13, s[44:47], s14 offen offset:1024 nt lds
buffer_load_dwordx4 v14, s[44:47], s14 offen offset:2048 nt lds
buffer_load_dwordx4 v15, s[44:47], s14 offen offset:3072 nt lds
s_and_b32 s14, s13, 0xf000
s_add_u32 s14, s14, s12
s_add_u32 s13, s13, 0x1000
s_mov_b32 m0, 0x8000
s_waitcnt vmcnt(31)
buffer_load_dwordx4 v12, s[44:47], s14 offen offset:0 nt lds
s_waitcnt vmcnt(31)
buffer_load_dwordx4 v13, s[44:47], s14 offen offset:1024 nt lds
s_waitcnt vmcnt(31)
buffer_load_dwordx4 v14, s[44:47], s14 offen offset:2048 nt lds
s_waitcnt vmcnt(31)
v_mov_b32 v10, 1
ds_write_b32 v9, v10
buffer_load_dwordx4 v15, s[44:47], s14 offen offset:3072 nt lds
s_and_b32 s14, s13, 0xf000
s_add_u32 s14, s14, s12
s_add_u32 s13, s13, 0x1000
s_mov_b32 m0, 0x9000
s_waitcnt vmcnt(31)
buffer_load_dwordx4 v12, s[44:47], s14 offen offset:0 nt lds
s_waitcnt vmcnt(31)
buffer_load_dwordx4 v13, s[44:47], s14 offen offset:1024 nt lds
s_waitcnt vmcnt(31)
buffer_load_dwordx4 v14, s[44:47], s14 offen offset:2048 nt lds
s_waitcnt vmcnt(31)
v_mov_b32 v10, 2
ds_write_b32 v9, v10
buffer_load_dwordx4 v15, s[44:47], s14 offen offset:3072 nt lds
s_and_b32 s14, s13, 0xf000
s_add_u32 s14, s14, s12
s_add_u32 s13, s13, 0x1000
s_mov_b32 m0, 0xa000
s_waitcnt vmcnt(31)
buffer_load_dwordx4 v12, s[44:47], s14 offen offset:0 nt lds
s_waitcnt vmcnt(31)
buffer_load_dwordx4 v13, s[44:47], s14 offen offset:1024 nt lds
s_waitcnt vmcnt(31)
buffer_load_dwordx4 v14, s[44:47], s14 offen offset:2048 nt lds
s_waitcnt vmcnt(31)
v_mov_b32 v10, 3
ds_write_b32 v9, v10
buffer_load_dwordx4 v15, s[44:47], s14 offen offset:3072 nt lds
s_and_b32 s14, s13, 0xf000
s_add_u32 s14, s14, s12
s_add_u32 s13, s13, 0x1000
s_mov_b32 m0, 0xb000
s_waitcnt vmcnt(31)
buffer_load_dwordx4 v12, s[44:47], s14 offen offset:0 nt lds
s_waitcnt vmcnt(31)
buffer_load_dwordx4 v13, s[44:47], s14 offen offset:1024 nt lds
s_waitcnt vmcnt(31)
buffer_load_dwordx4 v14, s[44:47], s14 offen offset:2048 nt lds
s_waitcnt vmcnt(31)
v_mov_b32 v10, 4
ds_write_b32 v9, v10
buffer_load_dwordx4 v15, s[44:47], s14 offen offset:3072 nt lds
s_and_b32 s14, s13, 0xf000
s_add_u32 s14, s14, s12
s_add_u32 s13, s13, 0x1000
s_mov_b32 m0, 0xc000
s_waitcnt vmcnt(31)
buffer_load_dwordx4 v12, s[44:47], s14 offen offset:0 nt lds
s_waitcnt vmcnt(31)
buffer_load_dwordx4 v13, s[44:47], s14 offen offset:1024 nt lds
s_waitcnt vmcnt(31)
buffer_load_dwordx4 v14, s[44:47], s14 offen offset:2048 nt lds
s_waitcnt vmcnt(31)
v_mov_b32 v10, 5
ds_write_b32 v9, v10
buffer_load_dwordx4 v15, s[44:47], s14 offen offset:3072 nt lds
s_and_b32 s14, s13, 0xf000
s_add_u32 s14, s14, s12
s_add_u32 s13, s13, 0x1000
s_mov_b32 m0, 0xd000
s_waitcnt vmcnt(31)
buffer_load_dwordx4 v12, s[44:47], s14 offen offset:0 nt lds
s_waitcnt vmcnt(31)
buffer_load_dwordx4 v13, s[44:47], s14 offen offset:1024 nt lds
s_waitcnt vmcnt(31)
buffer_load_dwordx4 v14, s[44:47], s14 offen offset:2048 nt lds
s_waitcnt vmcnt(31)
v_mov_b32 v10, 6
ds_write_b32 v9, v10
buffer_load_dwordx4 v15, s[44:47], s14 offen offset:3072 nt lds
s_and_b32 s14, s13, 0xf000
s_add_u32 s14, s14, s12
s_add_u32 s13, s13, 0x1000
s_mov_b32 m0, 0xe000
s_waitcnt vmcnt(31)
buffer_load_dwordx4 v12, s[44:47], s14 offen offset:0 nt lds
s_waitcnt vmcnt(31)
buffer_load_dwordx4 v13, s[44:47], s14 offen offset:1024 nt lds
s_waitcnt vmcnt(31)
buffer_load_dwordx4 v14, s[44:47], s14 offen offset:2048 nt lds
s_waitcnt vmcnt(31)
v_mov_b32 v10, 7
ds_write_b32 v9, v10
buffer_load_dwordx4 v15, s[44:47], s14 offen offset:3072 nt lds
s_and_b32 s14, s13, 0xf000
s_add_u32 s14, s14, s12
s_add_u32 s13, s13, 0x1000
s_mov_b32 m0, 0xf000
s_waitcnt vmcnt(31)
buffer_load_dwordx4 v12, s[44:47], s14 offen offset:0 nt lds
s_waitcnt vmcnt(31)
buffer_load_dwordx4 v13, s[44:47], s14 offen offset:1024 nt lds
s_waitcnt vmcnt(31)
buffer_load_dwordx4 v14, s[44:47], s14 offen offset:2048 nt lds
s_waitcnt vmcnt(31)
v_mov_b32 v10, 8
ds_write_b32 v9, v10
buffer_load_dwordx4 v15, s[44:47], s14 offen offset:3072 nt lds
s_and_b32 s14, s13, 0xf000
s_add_u32 s14, s14, s12
s_add_u32 s13, s13, 0x1000
s_mov_b32 m0, 0x10000
s_waitcnt vmcnt(31)
buffer_load_dwordx4 v3, s[48:51], s14 offen offset:0 nt lds
s_waitcnt vmcnt(31)
buffer_load_dwordx4 v3, s[48:51], s14 offen offset:1024 nt lds
s_waitcnt vmcnt(31)
buffer_load_dwordx4 v3, s[48:51], s14 offen offset:2048 nt lds
s_waitcnt vmcnt(31)
v_mov_b32 v10, 9
ds_write_b32 v9, v10
buffer_load_dwordx4 v3, s[48:51], s14 offen offset:3072 nt lds
s_and_b32 s14, s13, 0xf000
s_add_u32 s14, s14, s12
s_add_u32 s13, s13, 0x1000
s_mov_b32 m0, 0x11000
s_waitcnt vmcnt(31)
buffer_load_dwordx4 v3, s[48:51], s14 offen offset:0 nt lds
s_waitcnt vmcnt(31)
buffer_load_dwordx4 v3, s[48:51], s14 offen offset:1024 nt lds
s_waitcnt vmcnt(31)
buffer_load_dwordx4 v3, s[48:51], s14 offen offset:2048 nt lds
s_waitcnt vmcnt(31)
v_mov_b32 v10, 10
ds_write_b32 v9, v10
buffer_load_dwordx4 v3, s[48:51], s14 offen offset:3072 nt lds
s_and_b32 s14, s13, 0xf000
s_add_u32 s14, s14, s12
s_add_u32 s13, s13, 0x1000
s_mov_b32 m0, 0x12000
s_waitcnt vmcnt(31)
buffer_load_dwordx4 v3, s[48:51], s14 offen offset:0 nt lds
s_waitcnt vmcnt(31)
buffer_load_dwordx4 v3, s[48:51], s14 offen offset:1024 nt lds
s_waitcnt vmcnt(31)
buffer_load_dwordx4 v3, s[48:51], s14 offen offset:2048 nt lds
s_waitcnt vmcnt(31)
v_mov_b32 v10, 11
ds_write_b32 v9, v10
buffer_load_dwordx4 v3, s[48:51], s14 offen offset:3072 nt lds
s_and_b32 s14, s13, 0xf000
s_add_u32 s14, s14, s12
s_add_u32 s13, s13, 0x1000
s_mov_b32 m0, 0x13000
s_waitcnt vmcnt(31)
buffer_load_dwordx4 v3, s[48:51], s14 offen offset:0 nt lds
s_waitcnt vmcnt(31)
buffer_load_dwordx4 v3, s[48:51], s14 offen offset:1024 nt lds
s_waitcnt vmcnt(31)
buffer_load_dwordx4 v3, s[48:51], s14 offen offset:2048 nt lds
s_waitcnt vmcnt(31)
v_mov_b32 v10, 12
ds_write_b32 v9, v10
buffer_load_dwordx4 v3, s[48:51], s14 offen offset:3072 nt lds
s_and_b32 s14, s13, 0xf000
s_add_u32 s14, s14, s12
s_add_u32 s13, s13, 0x1000
s_mov_b32 m0, 0x14000
s_waitcnt vmcnt(31)
buffer_load_dwordx4 v3, s[48:51], s14 offen offset:0 nt lds
s_waitcnt vmcnt(31)
buffer_load_dwordx4 v3, s[48:51], s14 offen offset:1024 nt lds
s_waitcnt vmcnt(31)
buffer_load_dwordx4 v3, s[48:51], s14 offen offset:2048 nt lds
s_waitcnt vmcnt(31)
v_mov_b32 v10, 13
ds_write_b32 v9, v10
buffer_load_dwordx4 v3, s[48:51], s14 offen offset:3072 nt lds
s_and_b32 s14, s13, 0xf000
s_add_u32 s14, s14, s12
s_add_u32 s13, s13, 0x1000
s_mov_b32 m0, 0x15000
s_waitcnt vmcnt(31)
buffer_load_dwordx4 v3, s[48:51], s14 offen offset:0 nt lds
s_waitcnt vmcnt(31)
buffer_load_dwordx4 v3, s[48:51], s14 offen offset:1024 nt lds
s_waitcnt vmcnt(31)
buffer_load_dwordx4 v3, s[48:51], s14 offen offset:2048 nt lds
s_waitcnt vmcnt(31)
v_mov_b32 v10, 14
ds_write_b32 v9, v10
buffer_load_dwordx4 v3, s[48:51], s14 offen offset:3072 nt lds
s_and_b32 s14, s13, 0xf000
s_add_u32 s14, s14, s12
s_add_u32 s13, s13, 0x1000
s_mov_b32 m0, 0x16000
s_waitcnt vmcnt(31)
buffer_load_dwordx4 v3, s[48:51], s14 offen offset:0 nt lds
s_waitcnt vmcnt(31)
buffer_load_dwordx4 v3, s[48:51], s14 offen offset:1024 nt lds
s_waitcnt vmcnt(31)
buffer_load_dwordx4 v3, s[48:51], s14 offen offset:2048 nt lds
s_waitcnt vmcnt(31)
v_mov_b32 v10, 15
ds_write_b32 v9, v10
buffer_load_dwordx4 v3, s[48:51], s14 offen offset:3072 nt lds
s_and_b32 s14, s13, 0xf000
s_add_u32 s14, s14, s12
s_add_u32 s13, s13, 0x1000
s_mov_b32 m0, 0x17000
s_waitcnt vmcnt(31)
buffer_load_dwordx4 v3, s[48:51], s14 offen offset:0 nt lds
s_waitcnt vmcnt(31)
buffer_load_dwordx4 v3, s[48:51], s14 offen offset:1024 nt lds
s_waitcnt vmcnt(31)
buffer_load_dwordx4 v3, s[48:51], s14 offen offset:2048 nt lds
s_waitcnt vmcnt(31)
v_mov_b32 v10, 16
ds_write_b32 v9, v10
buffer_load_dwordx4 v3, s[48:51], s14 offen offset:3072 nt lds
s_and_b32 s14, s13, 0xf000
s_add_u32 s14, s14, s12
s_add_u32 s13, s13, 0x1000
s_mov_b32 m0, 0x18000
s_waitcnt vmcnt(31)
buffer_load_dwordx4 v3, s[48:51], s14 offen offset:0 nt lds
s_waitcnt vmcnt(31)
buffer_load_dwordx4 v3, s[48:51], s14 offen offset:1024 nt lds
s_waitcnt vmcnt(31)
buffer_load_dwordx4 v3, s[48:51], s14 offen offset:2048 nt lds
s_waitcnt vmcnt(31)
v_mov_b32 v10, 17
ds_write_b32 v9, v10
buffer_load_dwordx4 v3, s[48:51], s14 offen offset:3072 nt lds
s_and_b32 s14, s13, 0xf000
s_add_u32 s14, s14, s12
s_add_u32 s13, s13, 0x1000
s_mov_b32 m0, 0x19000
s_waitcnt vmcnt(31)
buffer_load_dwordx4 v3, s[48:51], s14 offen offset:0 nt lds
s_waitcnt vmcnt(31)
buffer_load_dwordx4 v3, s[48:51], s14 offen offset:1024 nt lds
s_waitcnt vmcnt(31)
buffer_load_dwordx4 v3, s[48:51], s14 offen offset:2048 nt lds
s_waitcnt vmcnt(31)
v_mov_b32 v10, 18
ds_write_b32 v9, v10
buffer_load_dwordx4 v3, s[48:51], s14 offen offset:3072 nt lds
s_and_b32 s14, s13, 0xf000
s_add_u32 s14, s14, s12
s_add_u32 s13, s13, 0x1000
s_mov_b32 m0, 0x1a000
s_waitcnt vmcnt(31)
buffer_load_dwordx4 v3, s[48:51], s14 offen offset:0 nt lds
s_waitcnt vmcnt(31)
buffer_load_dwordx4 v3, s[48:51], s14 offen offset:1024 nt lds
s_waitcnt vmcnt(31)
buffer_load_dwordx4 v3, s[48:51], s14 offen offset:2048 nt lds
s_waitcnt vmcnt(31)
v_mov_b32 v10, 19
ds_write_b32 v9, v10
buffer_load_dwordx4 v3, s[48:51], s14 offen offset:3072 nt lds
s_and_b32 s14, s13, 0xf000
s_add_u32 s14, s14, s12
s_add_u32 s13, s13, 0x1000
s_mov_b32 m0, 0x1b000
s_waitcnt vmcnt(31)
buffer_load_dwordx4 v3, s[48:51], s14 offen offset:0 nt lds
s_waitcnt vmcnt(31)
buffer_load_dwordx4 v3, s[48:51], s14 offen offset:1024 nt lds
s_waitcnt vmcnt(31)
buffer_load_dwordx4 v3, s[48:51], s14 offen offset:2048 nt lds
s_waitcnt vmcnt(31)
v_mov_b32 v10, 20
ds_write_b32 v9, v10
buffer_load_dwordx4 v3, s[48:51], s14 offen offset:3072 nt lds
s_and_b32 s14, s13, 0xf000
s_add_u32 s14, s14, s12
s_add_u32 s13, s13, 0x1000
s_mov_b32 m0, 0x1c000
s_waitcnt vmcnt(31)
buffer_load_dwordx4 v3, s[48:51], s14 offen offset:0 nt lds
s_waitcnt vmcnt(31)
buffer_load_dwordx4 v3, s[48:51], s14 offen offset:1024 nt lds
s_waitcnt vmcnt(31)
buffer_load_dwordx4 v3, s[48:51], s14 offen offset:2048 nt lds
s_waitcnt vmcnt(31)
v_mov_b32 v10, 21
ds_write_b32 v9, v10
buffer_load_dwordx4 v3, s[48:51], s14 offen offset:3072 nt lds
s_and_b32 s14, s13, 0xf000
s_add_u32 s14, s14, s12
s_add_u32 s13, s13, 0x1000
s_mov_b32 m0, 0x1d000
s_waitcnt vmcnt(31)
buffer_load_dwordx4 v3, s[48:51], s14 offen offset:0 nt lds
s_waitcnt vmcnt(31)
buffer_load_dwordx4 v3, s[48:51], s14 offen offset:1024 nt lds
s_waitcnt vmcnt(31)
buffer_load_dwordx4 v3, s[48:51], s14 offen offset:2048 nt lds
s_waitcnt vmcnt(31)
v_mov_b32 v10, 22
ds_write_b32 v9, v10
buffer_load_dwordx4 v3, s[48:51], s14 offen offset:3072 nt lds
s_and_b32 s14, s13, 0xf000
s_add_u32 s14, s14, s12
s_add_u32 s13, s13, 0x1000
s_mov_b32 m0, 0x1e000
s_waitcnt vmcnt(31)
buffer_load_dwordx4 v3, s[48:51], s14 offen offset:0 nt lds
s_waitcnt vmcnt(31)
buffer_load_dwordx4 v3, s[48:51], s14 offen offset:1024 nt lds
s_waitcnt vmcnt(31)
buffer_load_dwordx4 v3, s[48:51], s14 offen offset:2048 nt lds
s_waitcnt vmcnt(31)
v_mov_b32 v10, 23
ds_write_b32 v9, v10
buffer_load_dwordx4 v3, s[48:51], s14 offen offset:3072 nt lds
s_and_b32 s14, s13, 0xf000
s_add_u32 s14, s14, s12
s_add_u32 s13, s13, 0x1000
s_mov_b32 m0, 0x1f000
s_waitcnt vmcnt(31)
buffer_load_dwordx4 v3, s[48:51], s14 offen offset:0 nt lds
s_waitcnt vmcnt(31)
buffer_load_dwordx4 v3, s[48:51], s14 offen offset:1024 nt lds
s_waitcnt vmcnt(31)
buffer_load_dwordx4 v3, s[48:51], s14 offen offset:2048 nt lds
s_waitcnt vmcnt(31)
v_mov_b32 v10, 24
ds_write_b32 v9, v10
buffer_load_dwordx4 v3, s[48:51], s14 offen offset:3072 nt lds
s_waitcnt vmcnt(28)
v_mov_b32 v10, 25
ds_write_b32 v9, v10
s_waitcnt vmcnt(24)
v_mov_b32 v10, 26
ds_write_b32 v9, v10
s_waitcnt vmcnt(20)
v_mov_b32 v10, 27
ds_write_b32 v9, v10
s_waitcnt vmcnt(16)
v_mov_b32 v10, 28
ds_write_b32 v9, v10
s_waitcnt vmcnt(12)
v_mov_b32 v10, 29
ds_write_b32 v9, v10
s_waitcnt vmcnt(8)
v_mov_b32 v10, 30
ds_write_b32 v9, v10
s_waitcnt vmcnt(4)
v_mov_b32 v10, 31
ds_write_b32 v9, v10
s_waitcnt vmcnt(0)
v_mov_b32 v10, 32
ds_write_b32 v9, v10
s_branch L_Lred
.p2align 6
L_QH2:
s_mov_b32 s52, s38
s_mov_b32 s53, s39
s_mov_b32 s54, 0x268000
s_mov_b32 s55, 0x20000
s_mov_b32 s41, 0xfff
s_mul_i32 s13, s10, 36864
s_lshl_b32 s8, s15, 1
s_add_u32 s13, s13, s8
s_add_u32 s13, s13, 0xc1000
s_lshl_b32 s8, s4, 14
s_lshl_b32 s9, s12, 10
s_add_u32 s8, s8, s9
s_and_b32 s9, s7, 1
s_lshl_b32 s9, s9, 9
s_add_u32 s8, s8, s9
s_add_u32 s8, s8, 0x1000
s_cmp_ge_u32 s2, 252
s_cselect_b32 s13, 0x7f000000, s13
s_cmp_eq_u32 s3, 0
s_cselect_b32 s13, s8, s13
s_mul_i32 s8, s3, 10240
s_add_u32 s8, s8, 8192
v_lshrrev_b32 v5, 1, v2
v_mul_u32_u24 v5, s8, v5
v_lshl_add_u32 v5, v1, 5, v5
v_and_b32 v6, 1, v2
v_lshl_add_u32 v5, v6, 4, v5
s_waitcnt lgkmcnt(0)
s_add_u32 s42, s40, 1
s_and_b32 s40, s42, s41
v_mov_b32 v7, s40
s_barrier
v_mov_b32 v120, 0x0c0c0100
v_mov_b32 v121, 0x01000c0c
s_mov_b32 s60, 0xaaaaaaaa
s_mov_b32 s61, 0xaaaaaaaa
v_cndmask_b32 v120, v120, v121, s[60:61]
v_mov_b32 v121, 0x0c0c0302
v_mov_b32 v122, 0x03020c0c
v_cndmask_b32 v121, v121, v122, s[60:61]
v_mov_b32 v122, 0x0c0c0c0c
s_mov_b32 s60, 0x3030303
s_mov_b32 s61, 0x3030303
v_cndmask_b32 v8, v122, v120, s[60:61]
v_cndmask_b32 v12, v122, v121, s[60:61]
s_mov_b32 s60, 0xc0c0c0c
s_mov_b32 s61, 0xc0c0c0c
v_cndmask_b32 v9, v122, v120, s[60:61]
v_cndmask_b32 v13, v122, v121, s[60:61]
s_mov_b32 s60, 0x30303030
s_mov_b32 s61, 0x30303030
v_cndmask_b32 v10, v122, v120, s[60:61]
v_cndmask_b32 v14, v122, v121, s[60:61]
s_mov_b32 s60, 0xc0c0c0c0
s_mov_b32 s61, 0xc0c0c0c0
v_cndmask_b32 v11, v122, v120, s[60:61]
v_cndmask_b32 v15, v122, v121, s[60:61]
v_mov_b32 v6, 0x20654
v_mov_b32 v3, 1
s_cmp_eq_u32 s3, 0
s_cselect_b32 s56, 0xf, s41
v_and_b32 v27, s56, v7
s_waitcnt vmcnt(22)
v_perm_b32 v28, v16, v16, v8
v_perm_b32 v29, v16, v16, v9
v_perm_b32 v30, v16, v16, v10
v_perm_b32 v31, v16, v16, v11
s_waitcnt vmcnt(21)
s_nop 0
v_mfma_f32_16x16x32_bf16 v[124:127], v[28:31], v[32:35], 0
v_perm_b32 v120, v16, v16, v12
v_perm_b32 v121, v16, v16, v13
v_perm_b32 v122, v16, v16, v14
v_perm_b32 v123, v16, v16, v15
s_waitcnt vmcnt(20)
s_nop 0
v_mfma_f32_16x16x32_bf16 v[124:127], v[120:123], v[36:39], v[124:127]
v_perm_b32 v28, v17, v17, v8
v_perm_b32 v29, v17, v17, v9
v_perm_b32 v30, v17, v17, v10
v_perm_b32 v31, v17, v17, v11
s_waitcnt vmcnt(19)
s_nop 0
v_mfma_f32_16x16x32_bf16 v[124:127], v[28:31], v[40:43], v[124:127]
v_perm_b32 v120, v17, v17, v12
v_perm_b32 v121, v17, v17, v13
v_perm_b32 v122, v17, v17, v14
v_perm_b32 v123, v17, v17, v15
s_waitcnt vmcnt(18)
s_nop 0
v_mfma_f32_16x16x32_bf16 v[124:127], v[120:123], v[44:47], v[124:127]
v_perm_b32 v28, v18, v18, v8
v_perm_b32 v29, v18, v18, v9
v_perm_b32 v30, v18, v18, v10
v_perm_b32 v31, v18, v18, v11
s_waitcnt vmcnt(17)
s_nop 0
v_mfma_f32_16x16x32_bf16 v[124:127], v[28:31], v[48:51], v[124:127]
v_perm_b32 v120, v18, v18, v12
v_perm_b32 v121, v18, v18, v13
v_perm_b32 v122, v18, v18, v14
v_perm_b32 v123, v18, v18, v15
s_waitcnt vmcnt(16)
s_nop 0
v_mfma_f32_16x16x32_bf16 v[124:127], v[120:123], v[52:55], v[124:127]
v_perm_b32 v28, v19, v19, v8
v_perm_b32 v29, v19, v19, v9
v_perm_b32 v30, v19, v19, v10
v_perm_b32 v31, v19, v19, v11
s_waitcnt vmcnt(15)
s_nop 0
v_mfma_f32_16x16x32_bf16 v[124:127], v[28:31], v[56:59], v[124:127]
v_perm_b32 v120, v19, v19, v12
v_perm_b32 v121, v19, v19, v13
v_perm_b32 v122, v19, v19, v14
v_perm_b32 v123, v19, v19, v15
s_waitcnt vmcnt(14)
s_nop 0
v_mfma_f32_16x16x32_bf16 v[124:127], v[120:123], v[60:63], v[124:127]
v_perm_b32 v28, v20, v20, v8
v_perm_b32 v29, v20, v20, v9
v_perm_b32 v30, v20, v20, v10
v_perm_b32 v31, v20, v20, v11
s_waitcnt vmcnt(13)
s_nop 0
v_mfma_f32_16x16x32_bf16 v[124:127], v[28:31], v[64:67], v[124:127]
v_perm_b32 v120, v20, v20, v12
v_perm_b32 v121, v20, v20, v13
v_perm_b32 v122, v20, v20, v14
v_perm_b32 v123, v20, v20, v15
s_waitcnt vmcnt(12)
s_nop 0
v_mfma_f32_16x16x32_bf16 v[124:127], v[120:123], v[68:71], v[124:127]
s_mov_b64 exec, 1
ds_add_u32 v6, v3
s_mov_b64 exec, -1
v_perm_b32 v28, v21, v21, v8
v_perm_b32 v29, v21, v21, v9
v_perm_b32 v30, v21, v21, v10
v_perm_b32 v31, v21, v21, v11
s_waitcnt vmcnt(11)
s_nop 0
v_mfma_f32_16x16x32_bf16 v[124:127], v[28:31], v[72:75], v[124:127]
v_perm_b32 v120, v21, v21, v12
v_perm_b32 v121, v21, v21, v13
v_perm_b32 v122, v21, v21, v14
v_perm_b32 v123, v21, v21, v15
s_waitcnt vmcnt(10)
s_nop 0
v_mfma_f32_16x16x32_bf16 v[124:127], v[120:123], v[76:79], v[124:127]
v_perm_b32 v28, v22, v22, v8
v_perm_b32 v29, v22, v22, v9
v_perm_b32 v30, v22, v22, v10
v_perm_b32 v31, v22, v22, v11
s_waitcnt vmcnt(9)
s_nop 0
v_mfma_f32_16x16x32_bf16 v[124:127], v[28:31], v[80:83], v[124:127]
v_perm_b32 v120, v22, v22, v12
v_perm_b32 v121, v22, v22, v13
v_perm_b32 v122, v22, v22, v14
v_perm_b32 v123, v22, v22, v15
s_waitcnt vmcnt(8)
s_nop 0
v_mfma_f32_16x16x32_bf16 v[124:127], v[120:123], v[84:87], v[124:127]
v_perm_b32 v28, v23, v23, v8
v_perm_b32 v29, v23, v23, v9
v_perm_b32 v30, v23, v23, v10
v_perm_b32 v31, v23, v23, v11
s_waitcnt vmcnt(7)
s_nop 0
v_mfma_f32_16x16x32_bf16 v[124:127], v[28:31], v[88:91], v[124:127]
v_perm_b32 v120, v23, v23, v12
v_perm_b32 v121, v23, v23, v13
v_perm_b32 v122, v23, v23, v14
v_perm_b32 v123, v23, v23, v15
s_waitcnt vmcnt(6)
s_nop 0
v_mfma_f32_16x16x32_bf16 v[124:127], v[120:123], v[92:95], v[124:127]
v_perm_b32 v28, v24, v24, v8
v_perm_b32 v29, v24, v24, v9
v_perm_b32 v30, v24, v24, v10
v_perm_b32 v31, v24, v24, v11
s_waitcnt vmcnt(5)
s_nop 0
v_mfma_f32_16x16x32_bf16 v[124:127], v[28:31], v[96:99], v[124:127]
v_perm_b32 v120, v24, v24, v12
v_perm_b32 v121, v24, v24, v13
v_perm_b32 v122, v24, v24, v14
v_perm_b32 v123, v24, v24, v15
s_waitcnt vmcnt(4)
s_nop 0
v_mfma_f32_16x16x32_bf16 v[124:127], v[120:123], v[100:103], v[124:127]
s_mov_b64 exec, 1
ds_add_u32 v6, v3
s_mov_b64 exec, -1
v_perm_b32 v28, v25, v25, v8
v_perm_b32 v29, v25, v25, v9
v_perm_b32 v30, v25, v25, v10
v_perm_b32 v31, v25, v25, v11
s_waitcnt vmcnt(3)
s_nop 0
v_mfma_f32_16x16x32_bf16 v[124:127], v[28:31], v[104:107], v[124:127]
v_perm_b32 v120, v25, v25, v12
v_perm_b32 v121, v25, v25, v13
v_perm_b32 v122, v25, v25, v14
v_perm_b32 v123, v25, v25, v15
s_waitcnt vmcnt(2)
s_nop 0
v_mfma_f32_16x16x32_bf16 v[124:127], v[120:123], v[108:111], v[124:127]
v_perm_b32 v28, v26, v26, v8
v_perm_b32 v29, v26, v26, v9
v_perm_b32 v30, v26, v26, v10
v_perm_b32 v31, v26, v26, v11
s_waitcnt vmcnt(1)
s_nop 0
v_mfma_f32_16x16x32_bf16 v[124:127], v[28:31], v[112:115], v[124:127]
v_perm_b32 v120, v26, v26, v12
v_perm_b32 v121, v26, v26, v13
v_perm_b32 v122, v26, v26, v14
v_perm_b32 v123, v26, v26, v15
s_waitcnt vmcnt(0)
s_nop 0
v_mfma_f32_16x16x32_bf16 v[124:127], v[120:123], v[116:119], v[124:127]
s_nop 7
v_bfi_b32 v124, s56, v7, v124
v_bfi_b32 v125, s56, v7, v125
v_bfi_b32 v126, s56, v7, v126
v_bfi_b32 v127, s56, v7, v127
buffer_store_dwordx4 v[124:127], v5, s[52:55], s13 offen sc1
s_cmp_lg_u32 s3, 0
s_cbranch_scc1 L_H2
s_getreg_b32 s15, hwreg(HW_REG_XCC_ID, 0, 3)
s_lshl_b32 s8, s42, 3
s_or_b32 s15, s15, s8
v_mov_b32 v25, v27
v_lshlrev_b32 v26, 7, v0
v_mov_b32 v27, s15
s_lshl_b32 s14, s4, 11
s_lshl_b32 s8, s7, 2
s_add_u32 s14, s14, s8
s_add_u32 s14, s14, 0x260000
s_mov_b64 exec, 0xffff
buffer_store_dword v27, v26, s[52:55], s14 offen sc1
s_mov_b64 exec, -1
v_lshlrev_b32 v5, 4, v0
s_lshl_b32 s13, s4, 1
s_add_u32 s13, s13, s5
s_lshl_b32 s13, s13, 13
s_add_u32 s13, s13, 0x1000
s_add_u32 s14, s13, 4096
s_lshl_b32 s8, s4, 4
s_add_u32 s8, s8, s7
s_lshl_b32 s8, s8, 7
s_add_u32 s8, s8, 0x260000
s_add_u32 s46, s38, s8
s_addc_u32 s47, s39, 0
s_mov_b32 s8, 1
s_mov_b32 s62, 131072
L_qprobe:
s_sleep 4
s_load_dwordx16 s[64:79], s[46:47], 0 glc
s_sub_u32 s62, s62, 1
s_cbranch_scc1 L_qfetch0
s_waitcnt lgkmcnt(0)
s_xor_b32 s8, s64, s15
s_xor_b32 s9, s65, s15
s_or_b32 s8, s8, s9
s_xor_b32 s9, s66, s15
s_or_b32 s8, s8, s9
s_xor_b32 s9, s67, s15
s_or_b32 s8, s8, s9
s_xor_b32 s9, s68, s15
s_or_b32 s8, s8, s9
s_xor_b32 s9, s69, s15
s_or_b32 s8, s8, s9
s_xor_b32 s9, s70, s15
s_or_b32 s8, s8, s9
s_xor_b32 s9, s71, s15
s_or_b32 s8, s8, s9
s_xor_b32 s9, s72, s15
s_or_b32 s8, s8, s9
s_xor_b32 s9, s73, s15
s_or_b32 s8, s8, s9
s_xor_b32 s9, s74, s15
s_or_b32 s8, s8, s9
s_xor_b32 s9, s75, s15
s_or_b32 s8, s8, s9
s_xor_b32 s9, s76, s15
s_or_b32 s8, s8, s9
s_xor_b32 s9, s77, s15
s_or_b32 s8, s8, s9
s_xor_b32 s9, s78, s15
s_or_b32 s8, s8, s9
s_xor_b32 s9, s79, s15
s_or_b32 s8, s8, s9
s_lshr_b32 s9, s8, 3
s_cbranch_scc1 L_qprobe
L_qfetch0:
s_mov_b32 s62, 131072
s_waitcnt lgkmcnt(0)
L_qfetch:
buffer_load_dwordx4 v[32:35], v5, s[52:55], s13 offen offset:0 sc1
buffer_load_dwordx4 v[36:39], v5, s[52:55], s13 offen offset:1024 sc1
buffer_load_dwordx4 v[40:43], v5, s[52:55], s13 offen offset:2048 sc1
buffer_load_dwordx4 v[44:47], v5, s[52:55], s13 offen offset:3072 sc1
buffer_load_dwordx4 v[48:51], v5, s[52:55], s14 offen offset:0 sc1
buffer_load_dwordx4 v[52:55], v5, s[52:55], s14 offen offset:1024 sc1
buffer_load_dwordx4 v[56:59], v5, s[52:55], s14 offen offset:2048 sc1
buffer_load_dwordx4 v[60:63], v5, s[52:55], s14 offen offset:3072 sc1
s_sub_u32 s62, s62, 1
s_cbranch_scc1 L_qgo
v_mov_b32 v6, 0
s_waitcnt vmcnt(7)
v_xor_b32 v32, v25, v32
v_xor_b32 v33, v25, v33
v_xor_b32 v34, v25, v34
v_xor_b32 v35, v25, v35
v_or3_b32 v6, v6, v32, v33
v_or3_b32 v6, v6, v34, v35
s_waitcnt vmcnt(6)
v_xor_b32 v36, v25, v36
v_xor_b32 v37, v25, v37
v_xor_b32 v38, v25, v38
v_xor_b32 v39, v25, v39
v_or3_b32 v6, v6, v36, v37
v_or3_b32 v6, v6, v38, v39
s_waitcnt vmcnt(5)
v_xor_b32 v40, v25, v40
v_xor_b32 v41, v25, v41
v_xor_b32 v42, v25, v42
v_xor_b32 v43, v25, v43
v_or3_b32 v6, v6, v40, v41
v_or3_b32 v6, v6, v42, v43
s_waitcnt vmcnt(4)
v_xor_b32 v44, v25, v44
v_xor_b32 v45, v25, v45
v_xor_b32 v46, v25, v46
v_xor_b32 v47, v25, v47
v_or3_b32 v6, v6, v44, v45
v_or3_b32 v6, v6, v46, v47
s_waitcnt vmcnt(3)
v_xor_b32 v48, v25, v48
v_xor_b32 v49, v25, v49
v_xor_b32 v50, v25, v50
v_xor_b32 v51, v25, v51
v_or3_b32 v6, v6, v48, v49
v_or3_b32 v6, v6, v50, v51
s_waitcnt vmcnt(2)
v_xor_b32 v52, v25, v52
v_xor_b32 v53, v25, v53
v_xor_b32 v54, v25, v54
v_xor_b32 v55, v25, v55
v_or3_b32 v6, v6, v52, v53
v_or3_b32 v6, v6, v54, v55
s_waitcnt vmcnt(1)
v_xor_b32 v56, v25, v56
v_xor_b32 v57, v25, v57
v_xor_b32 v58, v25, v58
v_xor_b32 v59, v25, v59
v_or3_b32 v6, v6, v56, v57
v_or3_b32 v6, v6, v58, v59
s_waitcnt vmcnt(0)
v_xor_b32 v60, v25, v60
v_xor_b32 v61, v25, v61
v_xor_b32 v62, v25, v62
v_xor_b32 v63, v25, v63
v_or3_b32 v6, v6, v60, v61
v_or3_b32 v6, v6, v62, v63
v_and_b32 v6, s56, v6
v_cmp_ne_u32 vcc, 0, v6
s_cbranch_vccnz L_qfetch
L_qgo:
s_waitcnt vmcnt(0)
v_pk_add_f32 v[32:33], v[32:33], v[36:37]
v_pk_add_f32 v[34:35], v[34:35], v[38:39]
v_pk_add_f32 v[40:41], v[40:41], v[44:45]
v_pk_add_f32 v[42:43], v[42:43], v[46:47]
v_pk_add_f32 v[48:49], v[48:49], v[52:53]
v_pk_add_f32 v[50:51], v[50:51], v[54:55]
v_pk_add_f32 v[56:57], v[56:57], v[60:61]
v_pk_add_f32 v[58:59], v[58:59], v[62:63]
v_pk_add_f32 v[32:33], v[32:33], v[40:41]
v_pk_add_f32 v[34:35], v[34:35], v[42:43]
v_pk_add_f32 v[48:49], v[48:49], v[56:57]
v_pk_add_f32 v[50:51], v[50:51], v[58:59]
v_pk_add_f32 v[32:33], v[32:33], v[48:49]
v_pk_add_f32 v[34:35], v[34:35], v[50:51]
v_cvt_pk_bf16_f32 v32, v32, v33
v_cvt_pk_bf16_f32 v33, v34, v35
v_lshlrev_b32 v5, 3, v0
v_add_u32 v5, 0x20000, v5
ds_write_b64 v5, v[32:33]
s_cmp_eq_u32 s8, 0
s_cselect_b32 s9, 2, 1
v_mov_b32 v6, s9
v_mov_b32 v5, 0x20640
ds_write_b32 v5, v6
L_red:
s_lshr_b32 s14, s2, 4
s_lshl_b32 s14, s14, 3
s_and_b32 s8, s2, 7
s_add_u32 s14, s14, s8
s_lshl_b32 s14, s14, 1
s_bfe_u32 s8, s2, 0x10003
s_add_u32 s14, s14, s8
s_cmp_ge_u32 s14, 72
s_cbranch_scc1 L_fin1
s_setprio 0
v_lshlrev_b32 v5, 4, v0
v_and_b32 v6, 3, v0
v_lshrrev_b32 v5, 2, v0
v_mul_u32_u24 v5, 4608, v5
v_lshl_add_u32 v5, v6, 4, v5
s_mul_i32 s8, s3, 147456
s_lshl_b32 s9, s14, 6
s_add_u32 s8, s8, s9
s_add_u32 s8, s8, 0x100000
s_add_u32 s11, s8, 73728
v_bfe_u32 v8, v0, 2, 2
v_lshl_add_u32 v8, v6, 2, v8
v_lshlrev_b32 v8, 5, v8
s_lshl_b32 s10, s3, 2
s_add_u32 s10, s10, 0x21800
v_add_u32 v8, s10, v8
v_mov_b32 v11, 1
v_mov_b32 v10, 0x2064c
v_lshlrev_b32 v12, 5, v0
v_add_u32 v12, 0x21800, v12
v_lshlrev_b32 v13, 1, v0
s_mov_b32 s44, s34
s_mov_b32 s45, s35
s_mov_b32 s46, 0x900
s_mov_b32 s47, 0x20000
s_lshl_b32 s10, s14, 5
s_mov_b32 s64, 0x00f000f0
s_mov_b32 s65, 0x00f000f0
s_mov_b32 s66, 0x0f000f00
s_mov_b32 s67, 0x0f000f00
s_mov_b32 s68, 0xf000f000
s_mov_b32 s69, 0xf000f000
s_barrier
s_mov_b64 s[72:73], -1
s_mov_b64 s[74:75], -1
s_mov_b32 s62, 131072
L_fp2:
s_mov_b64 exec, s[72:73]
s_cbranch_execz L_sk4
buffer_load_dwordx4 v[16:19], v5, s[52:55], s8 offen sc1
L_sk4:
s_mov_b64 exec, s[74:75]
s_cbranch_execz L_sk5
buffer_load_dwordx4 v[20:23], v5, s[52:55], s11 offen sc1
L_sk5:
s_sub_u32 s62, s62, 1
s_cbranch_scc1 L_fpgo3
s_waitcnt vmcnt(0)
s_mov_b64 exec, s[72:73]
v_xor_b32 v16, v7, v16
v_xor_b32 v17, v7, v17
v_xor_b32 v18, v7, v18
v_xor_b32 v19, v7, v19
v_or3_b32 v9, v16, v17, v18
v_or_b32 v9, v9, v19
v_and_b32 v9, s41, v9
v_cmp_ne_u32 s[72:73], 0, v9
s_mov_b64 exec, s[74:75]
v_xor_b32 v20, v7, v20
v_xor_b32 v21, v7, v21
v_xor_b32 v22, v7, v22
v_xor_b32 v23, v7, v23
v_or3_b32 v9, v20, v21, v22
v_or_b32 v9, v9, v23
v_and_b32 v9, s41, v9
v_cmp_ne_u32 s[74:75], 0, v9
s_nop 0
s_or_b64 s[76:77], s[72:73], s[74:75]
s_cbranch_scc1 L_fp2
L_fpgo3:
s_mov_b64 exec, -1
s_waitcnt vmcnt(0)
v_add_f32 v16, v16, v20
v_add_f32 v17, v17, v21
v_add_f32 v18, v18, v22
v_add_f32 v19, v19, v23
v_add_f32_dpp v16, v16, v16 row_ror:4 row_mask:0xf bank_mask:0xf
v_add_f32_dpp v17, v17, v17 row_ror:4 row_mask:0xf bank_mask:0xf
v_add_f32_dpp v18, v18, v18 row_ror:4 row_mask:0xf bank_mask:0xf
v_add_f32_dpp v19, v19, v19 row_ror:4 row_mask:0xf bank_mask:0xf
v_add_f32_dpp v16, v16, v16 row_ror:8 row_mask:0xf bank_mask:0xf
v_add_f32_dpp v17, v17, v17 row_ror:8 row_mask:0xf bank_mask:0xf
v_add_f32_dpp v18, v18, v18 row_ror:8 row_mask:0xf bank_mask:0xf
v_add_f32_dpp v19, v19, v19 row_ror:8 row_mask:0xf bank_mask:0xf
v_cndmask_b32 v16, v16, v17, s[64:65]
v_cndmask_b32 v16, v16, v18, s[66:67]
v_cndmask_b32 v16, v16, v19, s[68:69]
v_mov_b32 v17, v16
s_nop 1
v_permlane16_swap_b32 v16, v17
s_nop 0
v_add_f32 v16, v16, v17
v_mov_b32 v17, v16
s_nop 1
v_permlane32_swap_b32 v16, v17
s_nop 0
v_add_f32 v16, v16, v17
s_mov_b64 exec, 0xffff
ds_write_b32 v8, v16
s_mov_b64 exec, 1
ds_add_rtn_u32 v9, v10, v11
s_mov_b64 exec, 0xffff
ds_read_b128 v[16:19], v12
ds_read_b128 v[20:23], v12 offset:16
s_waitcnt lgkmcnt(2)
v_readfirstlane_b32 s8, v9
s_cmp_lg_u32 s8, 7
s_cbranch_scc1 L_fin1
s_waitcnt lgkmcnt(0)
v_pk_add_f32 v[16:17], v[16:17], v[20:21]
v_pk_add_f32 v[18:19], v[18:19], v[22:23]
v_pk_add_f32 v[16:17], v[16:17], v[18:19]
v_add_f32 v16, v16, v17
v_cvt_pk_bf16_f32 v16, v16, v16
buffer_store_short v16, v13, s[44:47], s10 offen
s_mov_b64 exec, 1
s_cmp_lg_u32 s2, 0
s_cbranch_scc1 L_fin1
v_mov_b32 v9, s42
v_mov_b32 v8, 0
buffer_store_dword v9, v8, s[52:55], 0 offen offset:0
L_fin1:
s_endpgm
.p2align 6
L_H2:
v_and_b32 v6, 7, v0
v_lshlrev_b32 v6, 1, v6
v_bfe_u32 v9, v0, 3, 1
v_add_u32 v6, v6, v9
v_mul_u32_u24 v6, 18432, v6
v_mov_b32 v9, v6
v_lshl_add_u32 v6, v2, 4, v6
s_mul_i32 s11, s2, 72
s_add_u32 s11, s11, 0xc1000
s_and_b32 s8, s2, 1
s_lshl_b32 s8, s8, 3
s_sub_u32 s12, s11, s8
s_cmp_eq_u32 s8, 0
s_cselect_b32 s64, 0, -1
s_mov_b32 s65, s64
s_mov_b32 s66, 0xffff0000
s_mov_b32 s67, 0xffff0000
v_lshlrev_b32 v121, 4, v0
v_add_u32 v121, 0x21c00, v121
v_mov_b32 v120, 0x20658
v_mov_b32 v119, 1
v_mov_b32 v64, 0
v_mov_b32 v65, 0
v_mov_b32 v66, 0
v_mov_b32 v67, 0
v_mov_b32 v68, 0
v_mov_b32 v69, 0
v_mov_b32 v70, 0
v_mov_b32 v71, 0
s_mov_b32 s78, 0x7f7f7f7f
s_mov_b32 s79, 0x7f7f7f7f
v_mov_b32 v104, 0x20650
s_mov_b32 s62, 131072
L_hl6:
ds_read_b32 v105, v104
s_sub_u32 s62, s62, 1
s_waitcnt lgkmcnt(0)
v_readfirstlane_b32 s63, v105
s_cbranch_scc1 L_hld7
s_cmp_ge_u32 s63, 20
s_cbranch_scc1 L_hld7
s_sleep 4
s_branch L_hl6
L_hld7:
s_mov_b64 s[72:73], s[78:79]
s_mov_b64 s[74:75], s[78:79]
s_mov_b32 s62, 131072
L_hp8:
s_mov_b64 exec, s[72:73]
s_cbranch_execz L_sk10
buffer_load_dwordx4 v[64:67], v6, s[52:55], s11 offen sc1
L_sk10:
s_mov_b64 exec, s[74:75]
s_cbranch_execz L_sk11
buffer_load_dwordx4 v[68:71], v9, s[52:55], s12 offen offset:64 sc1
L_sk11:
s_sub_u32 s62, s62, 1
s_cbranch_scc1 L_hpgo9
s_waitcnt vmcnt(0)
s_mov_b64 exec, s[72:73]
v_xor_b32 v64, v7, v64
v_xor_b32 v65, v7, v65
v_xor_b32 v66, v7, v66
v_xor_b32 v67, v7, v67
v_or3_b32 v72, v64, v65, v66
v_or_b32 v72, v72, v67
v_and_b32 v72, s41, v72
v_cmp_ne_u32 s[72:73], 0, v72
s_mov_b64 exec, s[74:75]
v_xor_b32 v68, v7, v68
v_xor_b32 v69, v7, v69
v_xor_b32 v70, v7, v70
v_xor_b32 v71, v7, v71
v_or3_b32 v72, v68, v69, v70
v_or_b32 v72, v72, v71
v_and_b32 v72, s41, v72
v_cmp_ne_u32 s[74:75], 0, v72
s_nop 0
s_or_b64 s[76:77], s[72:73], s[74:75]
s_cbranch_scc1 L_hp8
L_hpgo9:
s_mov_b64 exec, -1
s_waitcnt vmcnt(0)
v_cndmask_b32 v68, v68, v70, s[64:65]
v_cndmask_b32 v69, v69, v71, s[64:65]
v_cndmask_b32 v68, v68, v69, s[66:67]
s_nop 0
v_add_f32_dpp v64, v64, v64 quad_perm:[1,0,3,2] row_mask:0xf bank_mask:0xf
v_add_f32_dpp v65, v65, v65 quad_perm:[1,0,3,2] row_mask:0xf bank_mask:0xf
v_add_f32_dpp v66, v66, v66 quad_perm:[1,0,3,2] row_mask:0xf bank_mask:0xf
v_add_f32_dpp v67, v67, v67 quad_perm:[1,0,3,2] row_mask:0xf bank_mask:0xf
v_add_f32_dpp v68, v68, v68 quad_perm:[1,0,3,2] row_mask:0xf bank_mask:0xf
v_add_f32_dpp v64, v64, v64 quad_perm:[2,3,0,1] row_mask:0xf bank_mask:0xf
v_add_f32_dpp v65, v65, v65 quad_perm:[2,3,0,1] row_mask:0xf bank_mask:0xf
v_add_f32_dpp v66, v66, v66 quad_perm:[2,3,0,1] row_mask:0xf bank_mask:0xf
v_add_f32_dpp v67, v67, v67 quad_perm:[2,3,0,1] row_mask:0xf bank_mask:0xf
v_add_f32_dpp v68, v68, v68 quad_perm:[2,3,0,1] row_mask:0xf bank_mask:0xf
v_add_f32_dpp v64, v64, v64 row_half_mirror row_mask:0xf bank_mask:0xf
v_add_f32_dpp v65, v65, v65 row_half_mirror row_mask:0xf bank_mask:0xf
v_add_f32_dpp v66, v66, v66 row_half_mirror row_mask:0xf bank_mask:0xf
v_add_f32_dpp v67, v67, v67 row_half_mirror row_mask:0xf bank_mask:0xf
v_add_f32_dpp v68, v68, v68 row_half_mirror row_mask:0xf bank_mask:0xf
v_max_f32 v64, 0, v64
v_max_f32 v65, 0, v65
v_max_f32 v66, 0, v66
v_max_f32 v67, 0, v67
v_max_f32 v68, 0, v68
v_cvt_pk_bf16_f32 v64, v64, v65
v_cvt_pk_bf16_f32 v65, v66, v67
v_cvt_pk_bf16_f32 v66, v68, v68
ds_write_b128 v121, v[64:67]
ds_write_b32 v120, v119
s_branch L_red
L_Lred:
s_branch L_red
.p2align 6
L_C:
s_setprio 2
s_sub_u32 s15, s3, 4
v_lshlrev_b32 v122, 4, v0
v_add_u32 v122, 0x20800, v122
s_lshl_b32 s8, s15, 10
v_add_u32 v125, s8, v122
s_waitcnt lgkmcnt(0)
s_add_u32 s42, s40, 1
s_and_b32 s40, s42, s41
v_mov_b32 v7, s40
s_barrier
v_mov_b32 v104, 0x0c0c0100
v_mov_b32 v105, 0x01000c0c
s_mov_b32 s60, 0xaaaaaaaa
s_mov_b32 s61, 0xaaaaaaaa
v_cndmask_b32 v104, v104, v105, s[60:61]
v_mov_b32 v105, 0x0c0c0302
v_mov_b32 v106, 0x03020c0c
v_cndmask_b32 v105, v105, v106, s[60:61]
v_mov_b32 v106, 0x0c0c0c0c
s_mov_b32 s60, 0x3030303
s_mov_b32 s61, 0x3030303
v_cndmask_b32 v8, v106, v104, s[60:61]
v_cndmask_b32 v12, v106, v105, s[60:61]
s_mov_b32 s60, 0xc0c0c0c
s_mov_b32 s61, 0xc0c0c0c
v_cndmask_b32 v9, v106, v104, s[60:61]
v_cndmask_b32 v13, v106, v105, s[60:61]
s_mov_b32 s60, 0x30303030
s_mov_b32 s61, 0x30303030
v_cndmask_b32 v10, v106, v104, s[60:61]
v_cndmask_b32 v14, v106, v105, s[60:61]
s_mov_b32 s60, 0xc0c0c0c0
s_mov_b32 s61, 0xc0c0c0c0
v_cndmask_b32 v11, v106, v104, s[60:61]
v_cndmask_b32 v15, v106, v105, s[60:61]
s_lshl_b32 s8, s15, 12
v_add_u32 v4, 0, v2
v_xor_b32 v4, v4, v1
v_lshlrev_b32 v4, 4, v4
v_lshl_add_u32 v4, v1, 8, v4
v_add_u32 v116, s8, v4
v_add_u32 v4, 4, v2
v_xor_b32 v4, v4, v1
v_lshlrev_b32 v4, 4, v4
v_lshl_add_u32 v4, v1, 8, v4
v_add_u32 v117, s8, v4
v_add_u32 v4, 8, v2
v_xor_b32 v4, v4, v1
v_lshlrev_b32 v4, 4, v4
v_lshl_add_u32 v4, v1, 8, v4
v_add_u32 v118, s8, v4
v_add_u32 v4, 12, v2
v_xor_b32 v4, v4, v1
v_lshlrev_b32 v4, 4, v4
v_lshl_add_u32 v4, v1, 8, v4
v_add_u32 v119, s8, v4
v_lshlrev_b32 v3, 4, v0
s_add_u32 s9, s8, 0x10000
v_add_u32 v3, s9, v3
v_and_b32 v5, 1, v0
v_lshlrev_b32 v5, 8, v5
v_lshl_add_u32 v5, v2, 4, v5
v_add_u32 v5, 0x20000, v5
s_lshl_b32 s8, s15, 8
s_add_u32 s8, s8, 0x20200
v_and_b32 v6, 3, v0
v_lshlrev_b32 v6, 5, v6
v_lshrrev_b32 v4, 2, v0
v_lshl_add_u32 v6, v4, 1, v6
v_add_u32 v6, s8, v6
v_bfe_u32 v4, v0, 3, 1
v_lshl_add_u32 v4, v4, 2, v2
v_lshlrev_b32 v4, 5, v4
v_add_u32 v123, s8, v4
v_lshrrev_b32 v124, 5, v0
v_lshlrev_b32 v124, 4, v124
v_add_u32 v124, 0x20600, v124
v_lshrrev_b32 v121, 5, v0
v_lshlrev_b32 v121, 3, v121
v_lshrrev_b32 v4, 1, v1
v_add_u32 v121, v121, v4
v_lshlrev_b32 v121, 7, v121
v_and_b32 v4, 1, v1
v_lshl_add_u32 v120, v4, 5, v121
v_and_b32 v4, 1, v2
v_lshl_add_u32 v120, v4, 4, v120
s_lshl_b32 s12, s4, 1
s_add_u32 s12, s12, s5
s_lshl_b32 s12, s12, 3
s_add_u32 s12, s12, s6
s_lshl_b32 s12, s12, 11
s_add_u32 s12, s12, 0x41000
s_mov_b32 s43, 0x3fb8aa3b
s_mov_b32 s74, 0x3db504f3
s_mov_b32 s64, 0xffff0000
s_mov_b32 s65, 0
s_mov_b32 s66, 0
s_mov_b32 s67, 0xffff
s_mov_b32 s68, 0
s_mov_b32 s69, 0xffff0000
v_mov_b32 v16, 0x20640
s_mov_b32 s62, 131072
L_qf12:
ds_read_b32 v17, v16
s_sub_u32 s62, s62, 1
s_waitcnt lgkmcnt(0)
v_readfirstlane_b32 s63, v17
s_cbranch_scc1 L_qfd13
s_cmp_ge_u32 s63, 1
s_cbranch_scc1 L_qfd13
s_sleep 2
s_branch L_qf12
L_qfd13:
s_mov_b32 s73, s63
ds_read_b128 v[80:83], v5 offset:0
ds_read_b128 v[84:87], v5 offset:64
ds_read_b128 v[88:91], v5 offset:128
ds_read_b128 v[92:95], v5 offset:192
s_add_u32 s13, s15, 13
v_mov_b32 v16, 0x20650
s_mov_b32 s62, 131072
L_kl14:
ds_read_b32 v17, v16
s_sub_u32 s62, s62, 1
s_waitcnt lgkmcnt(0)
v_readfirstlane_b32 s63, v17
s_cbranch_scc1 L_kld15
s_cmp_ge_u32 s63, s13
s_cbranch_scc1 L_kld15
s_sleep 1
s_branch L_kl14
L_kld15:
s_mov_b32 s72, s63
s_waitcnt vmcnt(0)
ds_read_b128 v[16:19], v116 offset:0
ds_read_b128 v[20:23], v117 offset:0
ds_read_b128 v[24:27], v118 offset:0
ds_read_b128 v[28:31], v119 offset:0
ds_read_b128 v[32:35], v116 offset:16384
ds_read_b128 v[36:39], v117 offset:16384
ds_read_b128 v[40:43], v118 offset:16384
ds_read_b128 v[44:47], v119 offset:16384
ds_read_b128 v[48:51], v116 offset:32768
ds_read_b128 v[52:55], v117 offset:32768
ds_read_b128 v[56:59], v118 offset:32768
ds_read_b128 v[60:63], v119 offset:32768
ds_read_b128 v[64:67], v116 offset:49152
ds_read_b128 v[68:71], v117 offset:49152
ds_read_b128 v[72:75], v118 offset:49152
ds_read_b128 v[76:79], v119 offset:49152
s_waitcnt lgkmcnt(12)
v_mfma_f32_16x16x32_bf16 v[96:99], v[80:83], v[16:19], 0
v_mfma_f32_16x16x32_bf16 v[96:99], v[84:87], v[20:23], v[96:99]
v_mfma_f32_16x16x32_bf16 v[96:99], v[88:91], v[24:27], v[96:99]
v_mfma_f32_16x16x32_bf16 v[96:99], v[92:95], v[28:31], v[96:99]
s_waitcnt lgkmcnt(8)
v_mfma_f32_16x16x32_bf16 v[100:103], v[80:83], v[32:35], 0
v_mfma_f32_16x16x32_bf16 v[100:103], v[84:87], v[36:39], v[100:103]
v_mfma_f32_16x16x32_bf16 v[100:103], v[88:91], v[40:43], v[100:103]
v_mfma_f32_16x16x32_bf16 v[100:103], v[92:95], v[44:47], v[100:103]
s_waitcnt lgkmcnt(4)
v_mfma_f32_16x16x32_bf16 v[104:107], v[80:83], v[48:51], 0
v_mfma_f32_16x16x32_bf16 v[104:107], v[84:87], v[52:55], v[104:107]
v_mfma_f32_16x16x32_bf16 v[104:107], v[88:91], v[56:59], v[104:107]
v_mfma_f32_16x16x32_bf16 v[104:107], v[92:95], v[60:63], v[104:107]
s_waitcnt lgkmcnt(0)
v_mfma_f32_16x16x32_bf16 v[108:111], v[80:83], v[64:67], 0
v_mfma_f32_16x16x32_bf16 v[108:111], v[84:87], v[68:71], v[108:111]
v_mfma_f32_16x16x32_bf16 v[108:111], v[88:91], v[72:75], v[108:111]
v_mfma_f32_16x16x32_bf16 v[108:111], v[92:95], v[76:79], v[108:111]
s_nop 7
v_cndmask_b32 v16, v96, v100, s[64:65]
v_cndmask_b32 v17, v97, v101, s[64:65]
v_cndmask_b32 v16, v16, v104, s[66:67]
v_cndmask_b32 v17, v17, v105, s[66:67]
v_cndmask_b32 v16, v16, v108, s[68:69]
v_cndmask_b32 v17, v17, v109, s[68:69]
v_cvt_pk_bf16_f32 v18, v16, v17
v_lshlrev_b32 v16, 16, v18
v_and_b32 v17, 0xffff0000, v18
v_mul_f32 v16, s74, v16
v_mul_f32 v17, s74, v17
v_cvt_pk_bf16_f32 v18, v16, v17
v_lshlrev_b32 v16, 16, v18
v_and_b32 v17, 0xffff0000, v18
v_mov_b32 v18, v16
v_mov_b32 v19, v17
s_nop 0
v_max_f32_dpp v18, v18, v18 quad_perm:[1,0,3,2] row_mask:0xf bank_mask:0xf
v_max_f32_dpp v19, v19, v19 quad_perm:[1,0,3,2] row_mask:0xf bank_mask:0xf
s_nop 0
v_max_f32_dpp v18, v18, v18 quad_perm:[2,3,0,1] row_mask:0xf bank_mask:0xf
v_max_f32_dpp v19, v19, v19 quad_perm:[2,3,0,1] row_mask:0xf bank_mask:0xf
s_nop 0
v_max_f32_dpp v18, v18, v18 row_half_mirror row_mask:0xf bank_mask:0xf
v_max_f32_dpp v19, v19, v19 row_half_mirror row_mask:0xf bank_mask:0xf
s_nop 0
v_max_f32_dpp v18, v18, v18 row_mirror row_mask:0xf bank_mask:0xf
v_max_f32_dpp v19, v19, v19 row_mirror row_mask:0xf bank_mask:0xf
v_mov_b32 v20, v18
v_mov_b32 v21, v19
s_nop 1
v_permlane16_swap_b32 v18, v20
v_permlane16_swap_b32 v19, v21
s_nop 0
v_max_f32 v18, v18, v20
v_max_f32 v19, v19, v21
v_mov_b32 v20, v18
v_mov_b32 v21, v19
s_nop 1
v_permlane32_swap_b32 v18, v20
v_permlane32_swap_b32 v19, v21
s_nop 0
v_max_f32 v18, v18, v20
v_max_f32 v19, v19, v21
v_sub_f32 v16, v16, v18
v_sub_f32 v17, v17, v19
v_mul_f32 v16, s43, v16
v_mul_f32 v17, s43, v17
v_exp_f32 v16, v16
v_exp_f32 v17, v17
s_nop 0
v_cvt_pk_bf16_f32 v22, v16, v17
ds_write_b16 v6, v22
ds_write_b16_d16_hi v6, v22 offset:128
ds_read_b128 v[80:83], v123
ds_read_b128 v[84:87], v123 offset:16
s_nop 0
v_add_f32_dpp v16, v16, v16 quad_perm:[1,0,3,2] row_mask:0xf bank_mask:0xf
v_add_f32_dpp v17, v17, v17 quad_perm:[1,0,3,2] row_mask:0xf bank_mask:0xf
s_nop 0
v_add_f32_dpp v16, v16, v16 quad_perm:[2,3,0,1] row_mask:0xf bank_mask:0xf
v_add_f32_dpp v17, v17, v17 quad_perm:[2,3,0,1] row_mask:0xf bank_mask:0xf
s_nop 0
v_add_f32_dpp v16, v16, v16 row_half_mirror row_mask:0xf bank_mask:0xf
v_add_f32_dpp v17, v17, v17 row_half_mirror row_mask:0xf bank_mask:0xf
s_nop 0
v_add_f32_dpp v16, v16, v16 row_mirror row_mask:0xf bank_mask:0xf
v_add_f32_dpp v17, v17, v17 row_mirror row_mask:0xf bank_mask:0xf
v_mov_b32 v20, v16
v_mov_b32 v21, v17
s_nop 1
v_permlane16_swap_b32 v16, v20
v_permlane16_swap_b32 v17, v21
s_nop 0
v_add_f32 v16, v16, v20
v_add_f32 v17, v17, v21
v_mov_b32 v20, v16
v_mov_b32 v21, v17
s_nop 1
v_permlane32_swap_b32 v16, v20
v_permlane32_swap_b32 v17, v21
s_nop 0
v_add_f32 v16, v16, v20
v_add_f32 v17, v17, v21
s_lshl_b32 s8, s15, 2
s_add_u32 s8, s8, 0x20600
v_mov_b32 v5, s8
s_mov_b32 s70, -1
s_mov_b32 s71, 0
v_cndmask_b32 v96, v19, v18, s[70:71]
s_mov_b64 exec, 1
ds_write2_b32 v5, v18, v19 offset0:0 offset1:4
ds_write2_b32 v5, v16, v17 offset0:8 offset1:12
v_mov_b32 v6, 1
v_mov_b32 v5, 0x20644
ds_add_u32 v5, v6
s_mov_b64 exec, -1
s_waitcnt lgkmcnt(0)
v_perm_b32 v32, v80, v80, v8
v_perm_b32 v33, v80, v80, v9
v_perm_b32 v34, v80, v80, v10
v_perm_b32 v35, v80, v80, v11
v_perm_b32 v36, v80, v80, v12
v_perm_b32 v37, v80, v80, v13
v_perm_b32 v38, v80, v80, v14
v_perm_b32 v39, v80, v80, v15
v_perm_b32 v40, v81, v81, v8
v_perm_b32 v41, v81, v81, v9
v_perm_b32 v42, v81, v81, v10
v_perm_b32 v43, v81, v81, v11
v_perm_b32 v44, v81, v81, v12
v_perm_b32 v45, v81, v81, v13
v_perm_b32 v46, v81, v81, v14
v_perm_b32 v47, v81, v81, v15
s_add_u32 s13, s15, 17
s_cmp_ge_u32 s72, s13
s_cbranch_scc1 L_vsk16
v_mov_b32 v104, 0x20650
s_mov_b32 s62, 131072
L_vl17:
ds_read_b32 v105, v104
s_sub_u32 s62, s62, 1
s_waitcnt lgkmcnt(0)
v_readfirstlane_b32 s63, v105
s_cbranch_scc1 L_vld18
s_cmp_ge_u32 s63, s13
s_cbranch_scc0 L_vl17
L_vld18:
s_mov_b32 s72, s63
L_vsk16:
ds_read_b128 v[16:19], v3 offset:0
ds_read_b128 v[20:23], v3 offset:1024
ds_read_b128 v[24:27], v3 offset:2048
ds_read_b128 v[28:31], v3 offset:3072
s_waitcnt lgkmcnt(3)
v_mfma_f32_16x16x32_bf16 v[112:115], v[32:35], v[16:19], 0
s_waitcnt lgkmcnt(2)
v_mfma_f32_16x16x32_bf16 v[112:115], v[36:39], v[20:23], v[112:115]
s_waitcnt lgkmcnt(1)
v_mfma_f32_16x16x32_bf16 v[112:115], v[40:43], v[24:27], v[112:115]
s_waitcnt lgkmcnt(0)
v_mfma_f32_16x16x32_bf16 v[112:115], v[44:47], v[28:31], v[112:115]
v_perm_b32 v32, v82, v82, v8
v_perm_b32 v33, v82, v82, v9
v_perm_b32 v34, v82, v82, v10
v_perm_b32 v35, v82, v82, v11
v_perm_b32 v36, v82, v82, v12
v_perm_b32 v37, v82, v82, v13
v_perm_b32 v38, v82, v82, v14
v_perm_b32 v39, v82, v82, v15
v_perm_b32 v40, v83, v83, v8
v_perm_b32 v41, v83, v83, v9
v_perm_b32 v42, v83, v83, v10
v_perm_b32 v43, v83, v83, v11
v_perm_b32 v44, v83, v83, v12
v_perm_b32 v45, v83, v83, v13
v_perm_b32 v46, v83, v83, v14
v_perm_b32 v47, v83, v83, v15
s_add_u32 s13, s15, 21
s_cmp_ge_u32 s72, s13
s_cbranch_scc1 L_vsk19
v_mov_b32 v104, 0x20650
s_mov_b32 s62, 131072
L_vl20:
ds_read_b32 v105, v104
s_sub_u32 s62, s62, 1
s_waitcnt lgkmcnt(0)
v_readfirstlane_b32 s63, v105
s_cbranch_scc1 L_vld21
s_cmp_ge_u32 s63, s13
s_cbranch_scc0 L_vl20
L_vld21:
s_mov_b32 s72, s63
L_vsk19:
ds_read_b128 v[16:19], v3 offset:16384
ds_read_b128 v[20:23], v3 offset:17408
ds_read_b128 v[24:27], v3 offset:18432
ds_read_b128 v[28:31], v3 offset:19456
s_waitcnt lgkmcnt(3)
v_mfma_f32_16x16x32_bf16 v[112:115], v[32:35], v[16:19], v[112:115]
s_waitcnt lgkmcnt(2)
v_mfma_f32_16x16x32_bf16 v[112:115], v[36:39], v[20:23], v[112:115]
s_waitcnt lgkmcnt(1)
v_mfma_f32_16x16x32_bf16 v[112:115], v[40:43], v[24:27], v[112:115]
s_waitcnt lgkmcnt(0)
v_mfma_f32_16x16x32_bf16 v[112:115], v[44:47], v[28:31], v[112:115]
v_perm_b32 v32, v84, v84, v8
v_perm_b32 v33, v84, v84, v9
v_perm_b32 v34, v84, v84, v10
v_perm_b32 v35, v84, v84, v11
v_perm_b32 v36, v84, v84, v12
v_perm_b32 v37, v84, v84, v13
v_perm_b32 v38, v84, v84, v14
v_perm_b32 v39, v84, v84, v15
v_perm_b32 v40, v85, v85, v8
v_perm_b32 v41, v85, v85, v9
v_perm_b32 v42, v85, v85, v10
v_perm_b32 v43, v85, v85, v11
v_perm_b32 v44, v85, v85, v12
v_perm_b32 v45, v85, v85, v13
v_perm_b32 v46, v85, v85, v14
v_perm_b32 v47, v85, v85, v15
s_add_u32 s13, s15, 25
s_cmp_ge_u32 s72, s13
s_cbranch_scc1 L_vsk22
v_mov_b32 v104, 0x20650
s_mov_b32 s62, 131072
L_vl23:
ds_read_b32 v105, v104
s_sub_u32 s62, s62, 1
s_waitcnt lgkmcnt(0)
v_readfirstlane_b32 s63, v105
s_cbranch_scc1 L_vld24
s_cmp_ge_u32 s63, s13
s_cbranch_scc0 L_vl23
L_vld24:
s_mov_b32 s72, s63
L_vsk22:
ds_read_b128 v[16:19], v3 offset:32768
ds_read_b128 v[20:23], v3 offset:33792
ds_read_b128 v[24:27], v3 offset:34816
ds_read_b128 v[28:31], v3 offset:35840
s_waitcnt lgkmcnt(3)
v_mfma_f32_16x16x32_bf16 v[112:115], v[32:35], v[16:19], v[112:115]
s_waitcnt lgkmcnt(2)
v_mfma_f32_16x16x32_bf16 v[112:115], v[36:39], v[20:23], v[112:115]
s_waitcnt lgkmcnt(1)
v_mfma_f32_16x16x32_bf16 v[112:115], v[40:43], v[24:27], v[112:115]
s_waitcnt lgkmcnt(0)
v_mfma_f32_16x16x32_bf16 v[112:115], v[44:47], v[28:31], v[112:115]
v_perm_b32 v32, v86, v86, v8
v_perm_b32 v33, v86, v86, v9
v_perm_b32 v34, v86, v86, v10
v_perm_b32 v35, v86, v86, v11
v_perm_b32 v36, v86, v86, v12
v_perm_b32 v37, v86, v86, v13
v_perm_b32 v38, v86, v86, v14
v_perm_b32 v39, v86, v86, v15
v_perm_b32 v40, v87, v87, v8
v_perm_b32 v41, v87, v87, v9
v_perm_b32 v42, v87, v87, v10
v_perm_b32 v43, v87, v87, v11
v_perm_b32 v44, v87, v87, v12
v_perm_b32 v45, v87, v87, v13
v_perm_b32 v46, v87, v87, v14
v_perm_b32 v47, v87, v87, v15
v_lshlrev_b32 v117, 11, v1
v_lshl_add_u32 v116, v2, 4, v117
s_lshl_b32 s75, s4, 15
s_lshl_b32 s8, s7, 7
s_add_u32 s75, s75, s8
s_add_u32 s75, s75, 0x41000
v_lshlrev_b32 v118, 3, v0
v_add_u32 v118, 0x22000, v118
v_mov_b32 v119, 0x2065c
v_mov_b32 v104, 0x20644
s_mov_b32 s62, 131072
L_pf25:
ds_read_b32 v105, v104
s_sub_u32 s62, s62, 1
s_waitcnt lgkmcnt(0)
v_readfirstlane_b32 s63, v105
s_cbranch_scc1 L_pfd26
s_cmp_ge_u32 s63, 4
s_cbranch_scc1 L_pfd26
s_sleep 1
s_branch L_pf25
L_pfd26:
ds_read_b128 v[88:91], v124
ds_read_b128 v[92:95], v124 offset:32
s_waitcnt lgkmcnt(0)
v_max3_f32 v97, v88, v89, v90
v_max_f32 v97, v97, v91
v_sub_f32 v88, v88, v97
v_sub_f32 v89, v89, v97
v_sub_f32 v90, v90, v97
v_sub_f32 v91, v91, v97
v_sub_f32 v96, v96, v97
v_mul_f32 v88, s43, v88
v_mul_f32 v89, s43, v89
v_mul_f32 v90, s43, v90
v_mul_f32 v91, s43, v91
v_mul_f32 v96, s43, v96
v_exp_f32 v88, v88
v_exp_f32 v89, v89
v_exp_f32 v90, v90
v_exp_f32 v91, v91
v_exp_f32 v96, v96
v_mul_f32 v99, v88, v92
v_fmac_f32 v99, v89, v93
v_fmac_f32 v99, v90, v94
v_fmac_f32 v99, v91, v95
v_bfi_b32 v100, s41, v7, v97
v_bfi_b32 v101, s41, v7, v99
v_and_b32 v102, s41, v97
v_lshl_or_b32 v102, v102, 12, v7
v_mov_b32 v103, v101
v_mov_b32 v106, 1
v_mov_b32 v107, 0x20648
s_add_u32 s13, s15, 29
s_cmp_ge_u32 s72, s13
s_cbranch_scc1 L_vsk27
v_mov_b32 v104, 0x20650
s_mov_b32 s62, 131072
L_vl28:
ds_read_b32 v105, v104
s_sub_u32 s62, s62, 1
s_waitcnt lgkmcnt(0)
v_readfirstlane_b32 s63, v105
s_cbranch_scc1 L_vld29
s_cmp_ge_u32 s63, s13
s_cbranch_scc0 L_vl28
L_vld29:
s_mov_b32 s72, s63
L_vsk27:
ds_read_b128 v[16:19], v3 offset:49152
ds_read_b128 v[20:23], v3 offset:50176
ds_read_b128 v[24:27], v3 offset:51200
ds_read_b128 v[28:31], v3 offset:52224
s_waitcnt lgkmcnt(3)
v_mfma_f32_16x16x32_bf16 v[112:115], v[32:35], v[16:19], v[112:115]
s_waitcnt lgkmcnt(2)
v_mfma_f32_16x16x32_bf16 v[112:115], v[36:39], v[20:23], v[112:115]
s_waitcnt lgkmcnt(1)
v_mfma_f32_16x16x32_bf16 v[112:115], v[40:43], v[24:27], v[112:115]
s_waitcnt lgkmcnt(0)
v_mfma_f32_16x16x32_bf16 v[112:115], v[44:47], v[28:31], v[112:115]
s_nop 7
v_mul_f32 v112, v96, v112
v_mul_f32 v113, v96, v113
v_mul_f32 v114, v96, v114
v_mul_f32 v115, v96, v115
ds_write_b128 v125, v[112:115]
s_mov_b64 exec, 1
ds_add_rtn_u32 v106, v107, v106
s_mov_b64 exec, -1
ds_read_b128 v[16:19], v122 offset:0
ds_read_b128 v[20:23], v122 offset:1024
ds_read_b128 v[24:27], v122 offset:2048
ds_read_b128 v[28:31], v122 offset:3072
s_waitcnt lgkmcnt(4)
v_readfirstlane_b32 s8, v106
s_cmp_lg_u32 s8, 3
s_cbranch_scc1 L_Cnopub
s_setprio 3
s_waitcnt lgkmcnt(2)
v_pk_add_f32 v[16:17], v[16:17], v[20:21]
v_pk_add_f32 v[18:19], v[18:19], v[22:23]
s_waitcnt lgkmcnt(0)
v_pk_add_f32 v[24:25], v[24:25], v[28:29]
v_pk_add_f32 v[26:27], v[26:27], v[30:31]
v_pk_add_f32 v[112:113], v[16:17], v[24:25]
v_pk_add_f32 v[114:115], v[18:19], v[26:27]
v_bfi_b32 v112, s41, v7, v112
v_bfi_b32 v113, s41, v7, v113
v_bfi_b32 v114, s41, v7, v114
v_bfi_b32 v115, s41, v7, v115
s_cmp_eq_u32 s73, 2
s_cbranch_scc1 L_Cfast
buffer_store_dwordx4 v[112:115], v120, s[52:55], s12 offen sc1
s_mov_b32 exec_lo, 0x5555
s_mov_b32 exec_hi, 0x5555
buffer_store_dwordx4 v[100:103], v121, s[52:55], s12 offen offset:64 sc1
s_branch L_Cpubd
L_Cfast:
buffer_store_dwordx4 v[112:115], v120, s[52:55], s12 offen
s_mov_b32 exec_lo, 0x5555
s_mov_b32 exec_hi, 0x5555
buffer_store_dwordx4 v[100:103], v121, s[52:55], s12 offen offset:64
L_Cpubd:
s_mov_b64 exec, -1
s_mov_b32 s78, s43
s_mov_b32 s43, s75
buffer_load_dwordx4 v[16:19], v116, s[52:55], s43 offen sc1
buffer_load_dwordx4 v[20:23], v117, s[52:55], s43 offen offset:64 sc1
ds_write_b32 v119, v119 offset:12
s_waitcnt vmcnt(0)
v_xor_b32 v64, v7, v16
v_xor_b32 v65, v7, v17
v_xor_b32 v66, v7, v18
v_xor_b32 v67, v7, v19
v_xor_b32 v68, v7, v20
v_xor_b32 v69, v7, v21
v_xor_b32 v70, v7, v22
v_xor_b32 v71, v7, v23
v_or3_b32 v74, v64, v65, v66
v_or3_b32 v74, v74, v67, v68
v_or3_b32 v74, v74, v69, v70
v_or_b32 v74, v74, v71
v_and_b32 v74, s41, v74
v_cmp_ne_u32 vcc, 0, v74
s_cbranch_vccz L_codone
s_mov_b64 s[72:73], -1
s_mov_b64 s[74:75], -1
s_mov_b32 s62, 131072
L_op30:
s_mov_b64 exec, s[72:73]
s_cbranch_execz L_sk32
buffer_load_dwordx4 v[64:67], v116, s[52:55], s43 offen sc1
L_sk32:
s_mov_b64 exec, s[74:75]
s_cbranch_execz L_sk33
buffer_load_dwordx4 v[68:71], v117, s[52:55], s43 offen offset:64 sc1
L_sk33:
s_sub_u32 s62, s62, 1
s_cbranch_scc1 L_opgo31
s_waitcnt vmcnt(0)
s_mov_b64 exec, s[72:73]
v_xor_b32 v64, v7, v64
v_xor_b32 v65, v7, v65
v_xor_b32 v66, v7, v66
v_xor_b32 v67, v7, v67
v_or3_b32 v74, v64, v65, v66
v_or_b32 v74, v74, v67
v_and_b32 v74, s41, v74
v_cmp_ne_u32 s[72:73], 0, v74
s_mov_b64 exec, s[74:75]
v_xor_b32 v68, v7, v68
v_xor_b32 v69, v7, v69
v_xor_b32 v70, v7, v70
v_xor_b32 v71, v7, v71
v_or3_b32 v74, v68, v69, v70
v_or_b32 v74, v74, v71
v_and_b32 v74, s41, v74
v_cmp_ne_u32 s[74:75], 0, v74
s_nop 0
s_or_b64 s[76:77], s[72:73], s[74:75]
s_cbranch_scc1 L_op30
L_opgo31:
s_mov_b64 exec, -1
s_waitcnt vmcnt(0)
L_codone:
v_lshrrev_b32 v70, 12, v70
v_or_b32 v68, v68, v70
v_mov_b32 v70, v68
s_nop 1
v_max_f32_dpp v70, v70, v70 quad_perm:[1,0,3,2] row_mask:0xf bank_mask:0xf
s_nop 1
v_max_f32_dpp v70, v70, v70 quad_perm:[2,3,0,1] row_mask:0xf bank_mask:0xf
s_nop 1
v_max_f32_dpp v70, v70, v70 row_half_mirror row_mask:0xf bank_mask:0xf
v_sub_f32 v68, v68, v70
v_mul_f32 v68, s78, v68
v_exp_f32 v68, v68
s_nop 0
v_mul_f32 v69, v68, v69
v_mul_f32 v64, v68, v64
v_mul_f32 v65, v68, v65
v_mul_f32 v66, v68, v66
v_mul_f32 v67, v68, v67
v_add_f32_dpp v69, v69, v69 quad_perm:[1,0,3,2] row_mask:0xf bank_mask:0xf
v_add_f32_dpp v64, v64, v64 quad_perm:[1,0,3,2] row_mask:0xf bank_mask:0xf
v_add_f32_dpp v65, v65, v65 quad_perm:[1,0,3,2] row_mask:0xf bank_mask:0xf
v_add_f32_dpp v66, v66, v66 quad_perm:[1,0,3,2] row_mask:0xf bank_mask:0xf
v_add_f32_dpp v67, v67, v67 quad_perm:[1,0,3,2] row_mask:0xf bank_mask:0xf
v_add_f32_dpp v69, v69, v69 quad_perm:[2,3,0,1] row_mask:0xf bank_mask:0xf
v_add_f32_dpp v64, v64, v64 quad_perm:[2,3,0,1] row_mask:0xf bank_mask:0xf
v_add_f32_dpp v65, v65, v65 quad_perm:[2,3,0,1] row_mask:0xf bank_mask:0xf
v_add_f32_dpp v66, v66, v66 quad_perm:[2,3,0,1] row_mask:0xf bank_mask:0xf
v_add_f32_dpp v67, v67, v67 quad_perm:[2,3,0,1] row_mask:0xf bank_mask:0xf
v_add_f32_dpp v69, v69, v69 row_half_mirror row_mask:0xf bank_mask:0xf
v_add_f32_dpp v64, v64, v64 row_half_mirror row_mask:0xf bank_mask:0xf
v_add_f32_dpp v65, v65, v65 row_half_mirror row_mask:0xf bank_mask:0xf
v_add_f32_dpp v66, v66, v66 row_half_mirror row_mask:0xf bank_mask:0xf
v_add_f32_dpp v67, v67, v67 row_half_mirror row_mask:0xf bank_mask:0xf
v_rcp_f32 v69, v69
s_nop 0
v_mul_f32 v64, v69, v64
v_mul_f32 v65, v69, v65
v_mul_f32 v66, v69, v66
v_mul_f32 v67, v69, v67
v_cvt_pk_bf16_f32 v64, v64, v65
v_cvt_pk_bf16_f32 v65, v66, v67
ds_write_b64 v118, v[64:65]
ds_write_b32 v119, v119
L_Cnopub:
s_waitcnt lgkmcnt(0)
s_branch L_red
.p2align 6
L_X:
v_and_b32 v9, 31, v0
v_mul_u32_u24 v9, 36, v9
v_lshrrev_b32 v10, 5, v0
v_mul_u32_u24 v10, 1152, v10
v_add_u32 v10, v10, v9
s_mov_b32 s44, s16
s_mov_b32 s45, s17
s_mov_b32 s46, 0x900
s_mov_b32 s47, 0x20000
s_mov_b32 s48, s32
s_mov_b32 s49, s33
s_mov_b32 s50, 0x480
s_mov_b32 s51, 0x20000
s_waitcnt lgkmcnt(0)
s_add_u32 s42, s40, 1
s_and_b32 s40, s42, s41
v_mov_b32 v7, s40
s_barrier
buffer_load_dwordx3 v[64:66], v10, s[44:47], 0 offen offset:0
buffer_load_dwordx3 v[68:70], v10, s[44:47], 0 offen offset:12
buffer_load_dwordx3 v[72:74], v10, s[44:47], 0 offen offset:24
buffer_load_dwordx3 v[80:82], v9, s[48:51], 0 offen offset:0
buffer_load_dwordx3 v[84:86], v9, s[48:51], 0 offen offset:12
buffer_load_dwordx3 v[88:90], v9, s[48:51], 0 offen offset:24
v_mov_b32 v100, 0
s_waitcnt vmcnt(0)
v_lshlrev_b32 v96, 16, v64
v_lshlrev_b32 v97, 16, v80
v_and_b32 v98, 0xffff0000, v64
v_and_b32 v99, 0xffff0000, v80
v_mul_f32 v96, v96, v97
v_mul_f32 v98, v98, v99
v_cvt_pk_bf16_f32 v96, v96, v98
v_lshlrev_b32 v97, 16, v96
v_and_b32 v98, 0xffff0000, v96
v_add_f32 v100, v100, v97
v_add_f32 v100, v100, v98
v_lshlrev_b32 v96, 16, v65
v_lshlrev_b32 v97, 16, v81
v_and_b32 v98, 0xffff0000, v65
v_and_b32 v99, 0xffff0000, v81
v_mul_f32 v96, v96, v97
v_mul_f32 v98, v98, v99
v_cvt_pk_bf16_f32 v96, v96, v98
v_lshlrev_b32 v97, 16, v96
v_and_b32 v98, 0xffff0000, v96
v_add_f32 v100, v100, v97
v_add_f32 v100, v100, v98
v_lshlrev_b32 v96, 16, v66
v_lshlrev_b32 v97, 16, v82
v_and_b32 v98, 0xffff0000, v66
v_and_b32 v99, 0xffff0000, v82
v_mul_f32 v96, v96, v97
v_mul_f32 v98, v98, v99
v_cvt_pk_bf16_f32 v96, v96, v98
v_lshlrev_b32 v97, 16, v96
v_and_b32 v98, 0xffff0000, v96
v_add_f32 v100, v100, v97
v_add_f32 v100, v100, v98
v_lshlrev_b32 v96, 16, v68
v_lshlrev_b32 v97, 16, v84
v_and_b32 v98, 0xffff0000, v68
v_and_b32 v99, 0xffff0000, v84
v_mul_f32 v96, v96, v97
v_mul_f32 v98, v98, v99
v_cvt_pk_bf16_f32 v96, v96, v98
v_lshlrev_b32 v97, 16, v96
v_and_b32 v98, 0xffff0000, v96
v_add_f32 v100, v100, v97
v_add_f32 v100, v100, v98
v_lshlrev_b32 v96, 16, v69
v_lshlrev_b32 v97, 16, v85
v_and_b32 v98, 0xffff0000, v69
v_and_b32 v99, 0xffff0000, v85
v_mul_f32 v96, v96, v97
v_mul_f32 v98, v98, v99
v_cvt_pk_bf16_f32 v96, v96, v98
v_lshlrev_b32 v97, 16, v96
v_and_b32 v98, 0xffff0000, v96
v_add_f32 v100, v100, v97
v_add_f32 v100, v100, v98
v_lshlrev_b32 v96, 16, v70
v_lshlrev_b32 v97, 16, v86
v_and_b32 v98, 0xffff0000, v70
v_and_b32 v99, 0xffff0000, v86
v_mul_f32 v96, v96, v97
v_mul_f32 v98, v98, v99
v_cvt_pk_bf16_f32 v96, v96, v98
v_lshlrev_b32 v97, 16, v96
v_and_b32 v98, 0xffff0000, v96
v_add_f32 v100, v100, v97
v_add_f32 v100, v100, v98
v_lshlrev_b32 v96, 16, v72
v_lshlrev_b32 v97, 16, v88
v_and_b32 v98, 0xffff0000, v72
v_and_b32 v99, 0xffff0000, v88
v_mul_f32 v96, v96, v97
v_mul_f32 v98, v98, v99
v_cvt_pk_bf16_f32 v96, v96, v98
v_lshlrev_b32 v97, 16, v96
v_and_b32 v98, 0xffff0000, v96
v_add_f32 v100, v100, v97
v_add_f32 v100, v100, v98
v_lshlrev_b32 v96, 16, v73
v_lshlrev_b32 v97, 16, v89
v_and_b32 v98, 0xffff0000, v73
v_and_b32 v99, 0xffff0000, v89
v_mul_f32 v96, v96, v97
v_mul_f32 v98, v98, v99
v_cvt_pk_bf16_f32 v96, v96, v98
v_lshlrev_b32 v97, 16, v96
v_and_b32 v98, 0xffff0000, v96
v_add_f32 v100, v100, v97
v_add_f32 v100, v100, v98
v_lshlrev_b32 v96, 16, v74
v_lshlrev_b32 v97, 16, v90
v_and_b32 v98, 0xffff0000, v74
v_and_b32 v99, 0xffff0000, v90
v_mul_f32 v96, v96, v97
v_mul_f32 v98, v98, v99
v_cvt_pk_bf16_f32 v96, v96, v98
v_lshlrev_b32 v97, 16, v96
v_and_b32 v98, 0xffff0000, v96
v_add_f32 v100, v100, v97
v_add_f32 v100, v100, v98
s_nop 1
v_add_f32_dpp v100, v100, v100 quad_perm:[1,0,3,2] row_mask:0xf bank_mask:0xf
s_nop 1
v_add_f32_dpp v100, v100, v100 quad_perm:[2,3,0,1] row_mask:0xf bank_mask:0xf
s_nop 1
v_add_f32_dpp v100, v100, v100 row_half_mirror row_mask:0xf bank_mask:0xf
s_nop 1
v_add_f32_dpp v100, v100, v100 row_mirror row_mask:0xf bank_mask:0xf
v_mov_b32 v101, v100
s_nop 1
v_permlane16_swap_b32 v100, v101
s_nop 0
v_add_f32 v100, v100, v101
v_cvt_pk_bf16_f32 v100, v100, v100
v_and_b32 v100, 0xffff0000, v100
v_mul_f32 v100, 0xbfb8aa3b, v100
v_exp_f32 v100, v100
s_nop 0
v_add_f32 v100, 1.0, v100
v_rcp_f32 v100, v100
s_nop 0
v_cvt_pk_bf16_f32 v100, v100, v100
v_and_b32 v100, 0xffff0000, v100
v_sub_f32 v101, 1.0, v100
v_cvt_pk_bf16_f32 v101, v101, v101
v_and_b32 v101, 0xffff0000, v101
v_lshrrev_b32 v9, 5, v0
v_lshlrev_b32 v9, 3, v9
v_add_u32 v9, 0x20680, v9
ds_write_b64 v9, v[100:101]
v_mov_b32 v9, 1
v_mov_b32 v10, 0x20690
ds_write_b32 v10, v9
s_branch L_red
.p2align 6
L_W:
s_sub_u32 s15, s3, 8
v_lshlrev_b32 v3, 4, v1
v_mov_b32 v9, 0x7f000000
s_cmp_eq_u32 s15, 4
s_cselect_b32 s60, 0xff00ff00, 0
s_mov_b32 s61, s60
v_cndmask_b32 v3, v3, v9, s[60:61]
v_mul_u32_u24 v4, 4608, v2
v_add_u32 v4, v4, v3
v_mul_u32_u24 v5, 1152, v2
v_add_u32 v5, v5, v3
s_mov_b32 s62, 0
s_mov_b32 s63, -1
v_cndmask_b32 v5, v5, v9, s[62:63]
s_lshl_b32 s8, s15, 8
s_mul_i32 s10, s2, 20736
s_add_u32 s10, s10, s8
s_add_u32 s13, s10, 18432
s_lshl_b32 s12, s4, 4
s_add_u32 s12, s12, s7
s_mul_i32 s12, s12, 18432
s_add_u32 s12, s12, s8
v_lshrrev_b32 v120, 5, v0
v_lshlrev_b32 v121, 3, v120
v_add_u32 v121, 0x20680, v121
v_mul_u32_u24 v120, 576, v120
v_lshl_add_u32 v120, v1, 3, v120
v_and_b32 v122, 1, v2
v_lshl_add_u32 v120, v122, 2, v120
s_lshl_b32 s8, s15, 7
v_add_u32 v120, s8, v120
v_lshlrev_b32 v120, 2, v120
v_cndmask_b32 v120, v120, v9, s[60:61]
s_and_b32 s14, s2, 7
s_lshl_b32 s14, s14, 5
s_lshr_b32 s8, s2, 3
s_add_u32 s14, s14, s8
s_lshl_b32 s14, s14, 6
s_mul_i32 s14, s14, 72
s_add_u32 s14, s14, 0x100000
v_lshlrev_b32 v122, 4, v0
v_add_u32 v122, 0x21c00, v122
v_lshlrev_b32 v123, 3, v0
v_add_u32 v123, 0x22000, v123
s_mov_b32 s44, s24
s_mov_b32 s45, s25
s_mov_b32 s46, 0x480000
s_mov_b32 s47, 0x20000
s_mov_b32 s48, s30
s_mov_b32 s49, s31
s_mov_b32 s50, 0x510000
s_mov_b32 s51, 0x20000
s_waitcnt lgkmcnt(0)
s_add_u32 s42, s40, 1
s_and_b32 s40, s42, s41
v_mov_b32 v7, s40
s_barrier
v_mov_b32 v104, 0x0c0c0100
v_mov_b32 v105, 0x01000c0c
s_mov_b32 s60, 0xaaaaaaaa
s_mov_b32 s61, 0xaaaaaaaa
v_cndmask_b32 v104, v104, v105, s[60:61]
v_mov_b32 v105, 0x0c0c0302
v_mov_b32 v106, 0x03020c0c
v_cndmask_b32 v105, v105, v106, s[60:61]
v_mov_b32 v106, 0x0c0c0c0c
s_mov_b32 s60, 0x3030303
s_mov_b32 s61, 0x3030303
v_cndmask_b32 v8, v106, v104, s[60:61]
v_cndmask_b32 v12, v106, v105, s[60:61]
s_mov_b32 s60, 0xc0c0c0c
s_mov_b32 s61, 0xc0c0c0c
v_cndmask_b32 v9, v106, v104, s[60:61]
v_cndmask_b32 v13, v106, v105, s[60:61]
s_mov_b32 s60, 0x30303030
s_mov_b32 s61, 0x30303030
v_cndmask_b32 v10, v106, v104, s[60:61]
v_cndmask_b32 v14, v106, v105, s[60:61]
s_mov_b32 s60, 0xc0c0c0c0
s_mov_b32 s61, 0xc0c0c0c0
v_cndmask_b32 v11, v106, v104, s[60:61]
v_cndmask_b32 v15, v106, v105, s[60:61]
s_mov_b32 s8, 0x1c71c75a
s_mul_i32 s9, s15, 6
s_lshr_b32 s8, s8, s9
s_and_b32 s64, s8, 63
v_mov_b32 v104, 0x20690
s_mov_b32 s62, 131072
L_gl34:
ds_read_b32 v105, v104
s_sub_u32 s62, s62, 1
s_waitcnt lgkmcnt(0)
v_readfirstlane_b32 s63, v105
s_cbranch_scc1 L_gld35
s_cmp_ge_u32 s63, 1
s_cbranch_scc1 L_gld35
s_sleep 4
s_branch L_gl34
L_gld35:
ds_read_b64 v[72:73], v121
v_mov_b32 v104, 0x20650
s_mov_b32 s62, 131072
L_wg36:
ds_read_b32 v105, v104
s_sub_u32 s62, s62, 1
s_waitcnt lgkmcnt(0)
v_readfirstlane_b32 s63, v105
s_cbranch_scc1 L_wgd37
s_cmp_ge_u32 s63, s64
s_cbranch_scc1 L_wgd37
s_sleep 2
s_branch L_wg36
L_wgd37:
s_cmp_lt_u32 s15, 2
s_cbranch_scc1 L_Wnopb
v_mov_b32 v104, 0x20668
s_mov_b32 s62, 131072
L_wpb38:
ds_read_b32 v105, v104
s_sub_u32 s62, s62, 1
s_waitcnt lgkmcnt(0)
v_readfirstlane_b32 s63, v105
s_cbranch_scc1 L_wpbd39
s_cmp_ge_u32 s63, 1
s_cbranch_scc0 L_wpb38
L_wpbd39:
L_Wnopb:
s_setprio 1
buffer_load_dwordx4 v[16:19], v4, s[48:51], s10 offen offset:0 nt
buffer_load_dwordx4 v[20:23], v4, s[48:51], s10 offen offset:1152 nt
buffer_load_dwordx4 v[24:27], v4, s[48:51], s10 offen offset:2304 nt
buffer_load_dwordx4 v[28:31], v4, s[48:51], s10 offen offset:3456 nt
buffer_load_dwordx4 v[32:35], v5, s[48:51], s13 offen nt
buffer_load_dwordx4 v[36:39], v4, s[44:47], s12 offen offset:0 nt
buffer_load_dwordx4 v[40:43], v4, s[44:47], s12 offen offset:1152 nt
buffer_load_dwordx4 v[44:47], v4, s[44:47], s12 offen offset:2304 nt
buffer_load_dwordx4 v[48:51], v4, s[44:47], s12 offen offset:3456 nt
v_mov_b32 v104, 0x20658
s_mov_b32 s62, 131072
L_yh40:
ds_read_b32 v105, v104
s_sub_u32 s62, s62, 1
s_waitcnt lgkmcnt(0)
v_readfirstlane_b32 s63, v105
s_cbranch_scc1 L_yhd41
s_cmp_ge_u32 s63, 1
s_cbranch_scc1 L_yhd41
s_sleep 1
s_branch L_yh40
L_yhd41:
ds_read_b128 v[64:67], v122
s_waitcnt lgkmcnt(0)
v_perm_b32 v104, v64, v64, v8
v_perm_b32 v105, v64, v64, v9
v_perm_b32 v106, v64, v64, v10
v_perm_b32 v107, v64, v64, v11
s_waitcnt vmcnt(8)
s_nop 0
v_mfma_f32_16x16x32_bf16 v[116:119], v[104:107], v[16:19], 0
v_perm_b32 v108, v64, v64, v12
v_perm_b32 v109, v64, v64, v13
v_perm_b32 v110, v64, v64, v14
v_perm_b32 v111, v64, v64, v15
s_waitcnt vmcnt(7)
s_nop 0
v_mfma_f32_16x16x32_bf16 v[116:119], v[108:111], v[20:23], v[116:119]
v_perm_b32 v104, v65, v65, v8
v_perm_b32 v105, v65, v65, v9
v_perm_b32 v106, v65, v65, v10
v_perm_b32 v107, v65, v65, v11
s_waitcnt vmcnt(6)
s_nop 0
v_mfma_f32_16x16x32_bf16 v[116:119], v[104:107], v[24:27], v[116:119]
v_perm_b32 v108, v65, v65, v12
v_perm_b32 v109, v65, v65, v13
v_perm_b32 v110, v65, v65, v14
v_perm_b32 v111, v65, v65, v15
s_waitcnt vmcnt(5)
s_nop 0
v_mfma_f32_16x16x32_bf16 v[116:119], v[108:111], v[28:31], v[116:119]
v_perm_b32 v104, v66, v66, v8
v_perm_b32 v105, v66, v66, v9
v_perm_b32 v106, v66, v66, v10
v_perm_b32 v107, v66, v66, v11
s_waitcnt vmcnt(4)
s_nop 0
v_mfma_f32_16x16x32_bf16 v[116:119], v[104:107], v[32:35], v[116:119]
s_nop 7
v_mul_f32 v116, v73, v116
v_mul_f32 v117, v73, v117
v_mul_f32 v118, v73, v118
v_mul_f32 v119, v73, v119
s_setprio 3
v_mov_b32 v104, 0x2065c
s_mov_b32 s62, 131072
L_yo42:
ds_read_b32 v105, v104
s_sub_u32 s62, s62, 1
s_waitcnt lgkmcnt(0)
v_readfirstlane_b32 s63, v105
s_cbranch_scc1 L_yod43
s_cmp_ge_u32 s63, 1
s_cbranch_scc0 L_yo42
L_yod43:
ds_read_b64 v[64:65], v123
s_waitcnt lgkmcnt(0)
v_perm_b32 v80, v64, v64, v8
v_perm_b32 v81, v64, v64, v9
v_perm_b32 v82, v64, v64, v10
v_perm_b32 v83, v64, v64, v11
v_perm_b32 v84, v64, v64, v12
v_perm_b32 v85, v64, v64, v13
v_perm_b32 v86, v64, v64, v14
v_perm_b32 v87, v64, v64, v15
s_waitcnt vmcnt(3)
v_mfma_f32_16x16x32_bf16 v[112:115], v[80:83], v[36:39], 0
v_perm_b32 v88, v65, v65, v8
v_perm_b32 v89, v65, v65, v9
v_perm_b32 v90, v65, v65, v10
v_perm_b32 v91, v65, v65, v11
s_waitcnt vmcnt(2)
v_mfma_f32_16x16x32_bf16 v[112:115], v[84:87], v[40:43], v[112:115]
v_perm_b32 v92, v65, v65, v12
v_perm_b32 v93, v65, v65, v13
v_perm_b32 v94, v65, v65, v14
v_perm_b32 v95, v65, v65, v15
s_waitcnt vmcnt(1)
v_mfma_f32_16x16x32_bf16 v[112:115], v[88:91], v[44:47], v[112:115]
s_waitcnt vmcnt(0)
v_mfma_f32_16x16x32_bf16 v[112:115], v[92:95], v[48:51], v[112:115]
s_nop 7
v_fma_f32 v112, v72, v112, v116
v_fma_f32 v113, v72, v113, v117
v_fma_f32 v114, v72, v114, v118
v_fma_f32 v115, v72, v115, v119
v_bfi_b32 v112, s41, v7, v112
v_bfi_b32 v113, s41, v7, v113
v_bfi_b32 v114, s41, v7, v114
v_bfi_b32 v115, s41, v7, v115
buffer_store_dwordx4 v[112:115], v120, s[52:55], s14 offen sc1
s_lshr_b32 s14, s2, 4
s_lshl_b32 s14, s14, 3
s_and_b32 s8, s2, 7
s_add_u32 s14, s14, s8
s_lshl_b32 s14, s14, 1
s_bfe_u32 s8, s2, 0x10003
s_add_u32 s14, s14, s8
s_cmp_ge_u32 s14, 72
s_cbranch_scc1 L_Wend
s_waitcnt vmcnt(0)
s_barrier
L_Wend:
L_end:
s_endpgm
L_code_end:
.section .rodata,"a"
.p2align 6
.amdhsa_kernel gated_mix__sliding_block_cached__dense_activation_relu__decode_kernel
  .amdhsa_next_free_vgpr 128
  .amdhsa_next_free_sgpr 102
  .amdhsa_accum_offset 128
  .amdhsa_group_segment_fixed_size 0
  .amdhsa_kernarg_size 96
  .amdhsa_user_sgpr_count 2
  .amdhsa_user_sgpr_kernarg_segment_ptr 1
  .amdhsa_system_sgpr_workgroup_id_x 1
  .amdhsa_float_denorm_mode_32 3
.end_amdhsa_kernel
```
